```python
import torch

def _softmax(x, axis=-1):
    return torch.softmax(x, dim=axis)

def _gelu(x):
    return torch.nn.functional.gelu(x, approximate='tanh')

def _silu(x):
    return torch.nn.functional.silu(x)

def _sigmoid(x):
    return torch.sigmoid(x)

def _layernorm(x, axis=-1, eps=1e-05):
    m = x.mean(dim=axis, keepdim=True)
    v = x.var(dim=axis, keepdim=True, unbiased=False)
    return (x - m) / torch.sqrt(v + eps)

def _scatter_add(tgt, idx, src, axis=0):
    return tgt.clone().index_add_(axis, idx, src)

def _segment_sum(src, seg, n):
    out = torch.zeros((n,) + src.shape[1:], dtype=src.dtype)
    return out.index_add_(0, seg, src)

def _pad(x, pw):
    flat = tuple((v for pair in reversed(pw) for v in pair))
    return torch.nn.functional.pad(x, flat)
kernel_name = 'gather_scatter__molecular_angular_painn__graph'

def setup_inputs():

    _w = lambda a: (lambda t: t.to(torch.bfloat16) if t.is_floating_point() else t)(torch.as_tensor(a))
    N, deg, D = (25000, 32, 64)
    n_rbf = max(0, 4)
    E = N * deg
    cutoff = 5.0
    freqs = (torch.arange(1, n_rbf + 1) * torch.pi / cutoff).to(float)
    return {'sv': _w((lambda *s: torch.randn(*s, dtype=torch.bfloat16) * 0.4)(N, 4, D) * 0.3), 'pos': _w((lambda *s: torch.randn(*s, dtype=torch.bfloat16) * 3.2)(N, 3) * 1.2), 'src': _w((lambda lo, hi, *s: torch.randint(lo, hi, s))(0, N, E).to(torch.int64)), 'dst': _w((lambda lo, hi, *s: torch.randint(lo, hi, s))(0, N, E).to(torch.int64)), 'freqs': _w(freqs), 'w_phi1': _w((lambda *s: torch.randn(*s, dtype=torch.bfloat16) * 3.2)(D, D) / D ** 0.5), 'w_phi2': _w((lambda *s: torch.randn(*s, dtype=torch.bfloat16) * 3.2)(D, 3 * D) / D ** 0.5), 'w_rbf': _w((lambda *s: torch.randn(*s, dtype=torch.bfloat16) * 3.2)(n_rbf, 3 * D) / n_rbf ** 0.5)}

def reference(sv, pos, src, dst, freqs, w_phi1, w_phi2, w_rbf):
    N, _, D = sv.shape
    E = src.shape[0]
    PI, cutoff = (3.141592653589793, 5.0)
    s, v = (sv[:, 0, :].clone(), sv[:, 1:, :].clone())
    r_vec = pos[src] - pos[dst]
    d = torch.sqrt((r_vec * r_vec).sum(-1) + 1e-08)
    r_hat = r_vec / d[:, None]
    rbf = torch.sin(d[:, None] * freqs[None, :]) / d[:, None]
    fcut = 0.5 * (torch.cos(PI * d / cutoff) + 1.0)
    fcut = torch.where(d < cutoff, fcut, 0.0 * d)
    Wf = rbf @ w_rbf * fcut[:, None]
    phi = (_silu(s @ w_phi1) @ w_phi2)[src]
    m = phi * Wf
    m_s, m_vv, m_vr = (m[:, :D].clone(), m[:, D:2 * D].clone(), m[:, 2 * D:].clone())
    ds = _segment_sum(m_s, dst, N)
    dv_e = m_vv[:, None, :] * v[src] + m_vr[:, None, :] * r_hat[:, :, None]
    dv = _segment_sum(dv_e.reshape(E, 3 * D), dst, N).reshape(N, 3, D)
    return sv + torch.concatenate([ds[:, None, :], dv], axis=1)
```

```asm
; @launch grid=(250,1,1) block=(512,1,1) lds=162048
.amdgcn_target "amdgcn-amd-amdhsa--gfx950"
.text
.globl gather_scatter__molecular_angular_painn__graph_kernel
.p2align 8
.type gather_scatter__molecular_angular_painn__graph_kernel,@function
gather_scatter__molecular_angular_painn__graph_kernel:
    s_cmp_ge_u32 s2, 250
    s_cbranch_scc1 L_end
    s_load_dwordx8 s[4:11], s[0:1], 0
    s_load_dwordx8 s[12:19], s[0:1], 32
    s_load_dwordx2 s[20:21], s[0:1], 64
    s_load_dwordx2 s[24:25], s[0:1], 80
    v_lshrrev_b32 v40, 6, v0
    v_and_b32 v41, 63, v0
    v_readfirstlane_b32 s3, v40
    v_lshlrev_b32 v1, 4, v41
    v_lshlrev_b32 v42, 4, v0
    v_and_b32 v44, 15, v41
    v_lshrrev_b32 v45, 4, v41
    v_lshlrev_b32 v7, 4, v45
    s_and_b32 s60, s3, 3
    s_lshl_b32 s60, s60, 4
    v_add_u32 v46, s60, v44
    v_lshl_add_u32 v64, v46, 9, v7
    v_lshl_add_u32 v65, v46, 7, v7
    v_lshrrev_b32 v43, 2, v42
    s_waitcnt lgkmcnt(0)
    s_mov_b32 s72, s6
    s_mov_b32 s73, s7
    s_mov_b32 s74, 150000
    s_mov_b32 s75, 0x20000
    s_mov_b32 s36, s6
    s_mov_b32 s37, s7
    s_mov_b32 s38, 150000
    s_mov_b32 s39, 0x20000
    s_lshr_b32 s63, s2, 3
    s_add_u32 s60, s63, s3
    s_sub_u32 s61, s60, 37
    s_cmp_ge_u32 s60, 37
    s_cselect_b32 s60, s61, s60
    s_lshl_b32 s61, s60, 12
    s_mov_b32 m0, s61
    s_add_u32 s60, s60, 8
    buffer_load_dwordx4 v1, s[72:75], s61 offen offset:0 lds
    buffer_load_dwordx4 v1, s[72:75], s61 offen offset:1024 lds
    buffer_load_dwordx4 v1, s[72:75], s61 offen offset:2048 lds
    buffer_load_dwordx4 v1, s[72:75], s61 offen offset:3072 lds
    s_mov_b32 s76, s14
    s_mov_b32 s77, s15
    s_mov_b32 s78, 8192
    s_mov_b32 s79, 0x20000
    s_lshl_b32 s61, s3, 10
    s_add_u32 m0, s61, 153856
    s_nop 0
    buffer_load_dwordx4 v1, s[76:79], s61 offen lds
    s_mul_i32 s46, s2, 51200
    s_add_u32 s44, s4, s46
    s_addc_u32 s45, s5, 0
    s_mov_b32 s46, 51200
    s_mov_b32 s47, 0x20000
    s_cmp_lt_u32 s3, 4
    s_cbranch_scc1 L1_nos
    buffer_load_dwordx4 v[68:71], v64, s[44:47], 0 offen
    buffer_load_dwordx4 v[72:75], v64, s[44:47], 0 offen offset:64
    v_add_u32 v64, 32768, v64
    buffer_load_dwordx4 v[76:79], v64, s[44:47], 0 offen
    buffer_load_dwordx4 v[80:83], v64, s[44:47], 0 offen offset:64
L1_nos:
    s_mul_i32 s66, s2, 12800
    s_add_u32 s64, s8, s66
    s_addc_u32 s65, s9, 0
    s_mov_b32 s66, 12800
    s_mov_b32 s67, 0x20000
    s_mul_i32 s70, s2, 12800
    s_add_u32 s68, s10, s70
    s_addc_u32 s69, s11, 0
    s_mov_b32 s70, 12800
    s_mov_b32 s71, 0x20000
    v_lshrrev_b32 v47, 1, v42
    v_add_u32 v47, 8192, v47
    buffer_load_dwordx4 v[48:51], v42, s[64:67], 0 offen nt
    buffer_load_dwordx4 v[56:59], v42, s[68:71], 0 offen nt
    buffer_load_dwordx2 v[52:53], v47, s[64:67], 0 offen nt
    buffer_load_dwordx2 v[60:61], v47, s[68:71], 0 offen nt
    v_add_u32 v47, 11776, v43
    s_sub_u32 s61, s3, 2
    s_cmp_lt_u32 s61, 2
    s_cselect_b32 s62, 0, 0x40000000
    v_add_u32 v47, s62, v47
    buffer_load_dword v54, v47, s[64:67], 0 offen nt
    buffer_load_dword v62, v47, s[68:71], 0 offen nt
    s_add_u32 s88, s24, 8322304
    s_addc_u32 s89, s25, 0
    s_load_dword s100, s[88:89], 0
    s_load_dwordx2 s[56:57], s[12:13], 0
    s_sub_u32 s61, s60, 37
    s_cmp_ge_u32 s60, 37
    s_cselect_b32 s60, s61, s60
    s_lshl_b32 s61, s60, 12
    s_mov_b32 m0, s61
    s_add_u32 s60, s60, 8
    buffer_load_dwordx4 v1, s[72:75], s61 offen offset:0 lds
    buffer_load_dwordx4 v1, s[72:75], s61 offen offset:1024 lds
    buffer_load_dwordx4 v1, s[72:75], s61 offen offset:2048 lds
    buffer_load_dwordx4 v1, s[72:75], s61 offen offset:3072 lds
    v_mov_b32 v40, 0
    v_add_u32 v47, 151552, v43
    s_cmp_ge_u32 s3, 5
    s_cbranch_scc1 L1_nozero
    ds_write_b32 v47, v40
L1_nozero:
    s_waitcnt vmcnt(10) lgkmcnt(0)
    s_mov_b32 s84, -100
    s_mov_b32 s85, 151552
    s_mov_b32 s86, 129024
    v_mov_b32 v47, 80
    s_barrier
    s_cmp_ge_u32 s3, 4
    s_cbranch_scc1 L1_hpath
    s_add_u32 s60, s63, s3
    s_add_u32 s60, s60, 16
    s_sub_u32 s61, s60, 37
    s_cmp_ge_u32 s60, 37
    s_cselect_b32 s60, s61, s60
    s_sub_u32 s61, s60, 37
    s_cmp_ge_u32 s60, 37
    s_cselect_b32 s60, s61, s60
    s_lshl_b32 s61, s60, 12
    s_mov_b32 m0, s61
    s_add_u32 s60, s60, 4
    buffer_load_dwordx4 v1, s[72:75], s61 offen offset:0 lds
    buffer_load_dwordx4 v1, s[72:75], s61 offen offset:1024 lds
    buffer_load_dwordx4 v1, s[72:75], s61 offen offset:2048 lds
    buffer_load_dwordx4 v1, s[72:75], s61 offen offset:3072 lds
    s_sub_u32 s61, s60, 37
    s_cmp_ge_u32 s60, 37
    s_cselect_b32 s60, s61, s60
    s_lshl_b32 s61, s60, 12
    s_mov_b32 m0, s61
    s_add_u32 s60, s60, 4
    buffer_load_dwordx4 v1, s[72:75], s61 offen offset:0 lds
    buffer_load_dwordx4 v1, s[72:75], s61 offen offset:1024 lds
    buffer_load_dwordx4 v1, s[72:75], s61 offen offset:2048 lds
    buffer_load_dwordx4 v1, s[72:75], s61 offen offset:3072 lds
    s_sub_u32 s61, s60, 37
    s_cmp_ge_u32 s60, 37
    s_cselect_b32 s60, s61, s60
    s_lshl_b32 s61, s60, 12
    s_mov_b32 m0, s61
    s_add_u32 s60, s60, 4
    buffer_load_dwordx4 v1, s[72:75], s61 offen offset:0 lds
    buffer_load_dwordx4 v1, s[72:75], s61 offen offset:1024 lds
    buffer_load_dwordx4 v1, s[72:75], s61 offen offset:2048 lds
    buffer_load_dwordx4 v1, s[72:75], s61 offen offset:3072 lds
    s_sub_u32 s61, s60, 37
    s_cmp_ge_u32 s60, 37
    s_cselect_b32 s60, s61, s60
    s_lshl_b32 s61, s60, 12
    s_mov_b32 m0, s61
    s_add_u32 s60, s60, 4
    buffer_load_dwordx4 v1, s[72:75], s61 offen offset:0 lds
    buffer_load_dwordx4 v1, s[72:75], s61 offen offset:1024 lds
    buffer_load_dwordx4 v1, s[72:75], s61 offen offset:2048 lds
    buffer_load_dwordx4 v1, s[72:75], s61 offen offset:3072 lds
    s_sub_u32 s61, s60, 37
    s_cmp_ge_u32 s60, 37
    s_cselect_b32 s60, s61, s60
    s_lshl_b32 s61, s60, 12
    s_mov_b32 m0, s61
    s_add_u32 s60, s60, 4
    buffer_load_dwordx4 v1, s[72:75], s61 offen offset:0 lds
    buffer_load_dwordx4 v1, s[72:75], s61 offen offset:1024 lds
    buffer_load_dwordx4 v1, s[72:75], s61 offen offset:2048 lds
    buffer_load_dwordx4 v1, s[72:75], s61 offen offset:3072 lds
    s_cmp_ge_u32 s3, 1
    s_cbranch_scc1 L1_tabdone
    s_sub_u32 s61, s60, 37
    s_cmp_ge_u32 s60, 37
    s_cselect_b32 s60, s61, s60
    s_lshl_b32 s61, s60, 12
    s_mov_b32 m0, s61
    s_add_u32 s60, s60, 4
    buffer_load_dwordx4 v1, s[72:75], s61 offen offset:0 lds
    buffer_load_dwordx4 v1, s[72:75], s61 offen offset:1024 lds
    buffer_load_dwordx4 v1, s[72:75], s61 offen offset:2048 lds
    buffer_load_dwordx4 v1, s[72:75], s61 offen offset:3072 lds
L1_tabdone:
    s_waitcnt vmcnt(24)
    s_branch L1_consts
L1_hpath:
    s_setprio 2
    s_mul_i32 s78, s2, 12800
    s_add_u32 s76, s24, s78
    s_addc_u32 s77, s25, 0
    s_mov_b32 s78, 12800
    s_mov_b32 s79, 0x20000
    v_lshrrev_b32 v66, 2, v44
    v_lshl_add_u32 v66, v45, 3, v66
    v_and_b32 v67, 3, v44
    v_lshlrev_b32 v67, 3, v67
    v_lshl_add_u32 v66, v66, 7, v67
    v_add_u32 v66, 153856, v66
    ds_read_b64_tr_b16 v[100:101], v66 offset:0
    ds_read_b64_tr_b16 v[102:103], v66 offset:512
    ds_read_b64_tr_b16 v[104:105], v66 offset:4096
    ds_read_b64_tr_b16 v[106:107], v66 offset:4608
    ds_read_b64_tr_b16 v[108:109], v66 offset:32
    ds_read_b64_tr_b16 v[110:111], v66 offset:544
    ds_read_b64_tr_b16 v[112:113], v66 offset:4128
    ds_read_b64_tr_b16 v[114:115], v66 offset:4640
    ds_read_b64_tr_b16 v[116:117], v66 offset:64
    ds_read_b64_tr_b16 v[118:119], v66 offset:576
    ds_read_b64_tr_b16 v[120:121], v66 offset:4160
    ds_read_b64_tr_b16 v[122:123], v66 offset:4672
    s_waitcnt lgkmcnt(4)
    ds_read_b64_tr_b16 v[124:125], v66 offset:96
    ds_read_b64_tr_b16 v[126:127], v66 offset:608
    ds_read_b64_tr_b16 v[128:129], v66 offset:4192
    ds_read_b64_tr_b16 v[130:131], v66 offset:4704
    s_waitcnt lgkmcnt(0)
    v_mfma_f32_16x16x32_bf16 v[132:135], v[100:103], v[68:71], 0
    v_mfma_f32_16x16x32_bf16 v[132:135], v[104:107], v[72:75], v[132:135]
    v_mfma_f32_16x16x32_bf16 v[136:139], v[108:111], v[68:71], 0
    v_mfma_f32_16x16x32_bf16 v[136:139], v[112:115], v[72:75], v[136:139]
    v_mfma_f32_16x16x32_bf16 v[140:143], v[116:119], v[68:71], 0
    v_mfma_f32_16x16x32_bf16 v[140:143], v[120:123], v[72:75], v[140:143]
    v_mfma_f32_16x16x32_bf16 v[144:147], v[124:127], v[68:71], 0
    v_mfma_f32_16x16x32_bf16 v[144:147], v[128:131], v[72:75], v[144:147]
    s_nop 1
    v_cvt_pk_bf16_f32 v132, 0, v132
    v_cvt_pk_bf16_f32 v133, 0, v133
    v_cvt_pk_bf16_f32 v134, 0, v134
    v_cvt_pk_bf16_f32 v135, 0, v135
    v_mul_f32 v164, 0xbfb8aa3b, v132
    v_mul_f32 v165, 0xbfb8aa3b, v133
    v_mul_f32 v166, 0xbfb8aa3b, v134
    v_mul_f32 v167, 0xbfb8aa3b, v135
    v_exp_f32 v164, v164
    v_exp_f32 v165, v165
    v_exp_f32 v166, v166
    v_exp_f32 v167, v167
    v_add_f32 v164, 1.0, v164
    v_add_f32 v165, 1.0, v165
    v_add_f32 v166, 1.0, v166
    v_add_f32 v167, 1.0, v167
    v_rcp_f32 v164, v164
    v_rcp_f32 v165, v165
    v_rcp_f32 v166, v166
    v_rcp_f32 v167, v167
    v_mul_f32 v164, v164, v132
    v_mul_f32 v165, v165, v133
    v_mul_f32 v166, v166, v134
    v_mul_f32 v167, v167, v135
    v_cvt_pk_bf16_f32 v148, v164, v165
    v_cvt_pk_bf16_f32 v149, v166, v167
    v_cvt_pk_bf16_f32 v136, 0, v136
    v_cvt_pk_bf16_f32 v137, 0, v137
    v_cvt_pk_bf16_f32 v138, 0, v138
    v_cvt_pk_bf16_f32 v139, 0, v139
    v_mul_f32 v164, 0xbfb8aa3b, v136
    v_mul_f32 v165, 0xbfb8aa3b, v137
    v_mul_f32 v166, 0xbfb8aa3b, v138
    v_mul_f32 v167, 0xbfb8aa3b, v139
    v_exp_f32 v164, v164
    v_exp_f32 v165, v165
    v_exp_f32 v166, v166
    v_exp_f32 v167, v167
    v_add_f32 v164, 1.0, v164
    v_add_f32 v165, 1.0, v165
    v_add_f32 v166, 1.0, v166
    v_add_f32 v167, 1.0, v167
    v_rcp_f32 v164, v164
    v_rcp_f32 v165, v165
    v_rcp_f32 v166, v166
    v_rcp_f32 v167, v167
    v_mul_f32 v164, v164, v136
    v_mul_f32 v165, v165, v137
    v_mul_f32 v166, v166, v138
    v_mul_f32 v167, v167, v139
    v_cvt_pk_bf16_f32 v150, v164, v165
    v_cvt_pk_bf16_f32 v151, v166, v167
    v_cvt_pk_bf16_f32 v140, 0, v140
    v_cvt_pk_bf16_f32 v141, 0, v141
    v_cvt_pk_bf16_f32 v142, 0, v142
    v_cvt_pk_bf16_f32 v143, 0, v143
    v_mul_f32 v164, 0xbfb8aa3b, v140
    v_mul_f32 v165, 0xbfb8aa3b, v141
    v_mul_f32 v166, 0xbfb8aa3b, v142
    v_mul_f32 v167, 0xbfb8aa3b, v143
    v_exp_f32 v164, v164
    v_exp_f32 v165, v165
    v_exp_f32 v166, v166
    v_exp_f32 v167, v167
    v_add_f32 v164, 1.0, v164
    v_add_f32 v165, 1.0, v165
    v_add_f32 v166, 1.0, v166
    v_add_f32 v167, 1.0, v167
    v_rcp_f32 v164, v164
    v_rcp_f32 v165, v165
    v_rcp_f32 v166, v166
    v_rcp_f32 v167, v167
    v_mul_f32 v164, v164, v140
    v_mul_f32 v165, v165, v141
    v_mul_f32 v166, v166, v142
    v_mul_f32 v167, v167, v143
    v_cvt_pk_bf16_f32 v152, v164, v165
    v_cvt_pk_bf16_f32 v153, v166, v167
    v_cvt_pk_bf16_f32 v144, 0, v144
    v_cvt_pk_bf16_f32 v145, 0, v145
    v_cvt_pk_bf16_f32 v146, 0, v146
    v_cvt_pk_bf16_f32 v147, 0, v147
    v_mul_f32 v164, 0xbfb8aa3b, v144
    v_mul_f32 v165, 0xbfb8aa3b, v145
    v_mul_f32 v166, 0xbfb8aa3b, v146
    v_mul_f32 v167, 0xbfb8aa3b, v147
    v_exp_f32 v164, v164
    v_exp_f32 v165, v165
    v_exp_f32 v166, v166
    v_exp_f32 v167, v167
    v_add_f32 v164, 1.0, v164
    v_add_f32 v165, 1.0, v165
    v_add_f32 v166, 1.0, v166
    v_add_f32 v167, 1.0, v167
    v_rcp_f32 v164, v164
    v_rcp_f32 v165, v165
    v_rcp_f32 v166, v166
    v_rcp_f32 v167, v167
    v_mul_f32 v164, v164, v144
    v_mul_f32 v165, v165, v145
    v_mul_f32 v166, v166, v146
    v_mul_f32 v167, v167, v147
    v_cvt_pk_bf16_f32 v154, v164, v165
    v_cvt_pk_bf16_f32 v155, v166, v167
    s_cmp_eq_u32 s3, 7
    s_nop 0
    s_cbranch_scc1 L1_hdone
    v_mfma_f32_16x16x32_bf16 v[132:135], v[100:103], v[76:79], 0
    v_mfma_f32_16x16x32_bf16 v[132:135], v[104:107], v[80:83], v[132:135]
    v_mfma_f32_16x16x32_bf16 v[136:139], v[108:111], v[76:79], 0
    v_mfma_f32_16x16x32_bf16 v[136:139], v[112:115], v[80:83], v[136:139]
    v_mfma_f32_16x16x32_bf16 v[140:143], v[116:119], v[76:79], 0
    v_mfma_f32_16x16x32_bf16 v[140:143], v[120:123], v[80:83], v[140:143]
    v_mfma_f32_16x16x32_bf16 v[144:147], v[124:127], v[76:79], 0
    v_mfma_f32_16x16x32_bf16 v[144:147], v[128:131], v[80:83], v[144:147]
    s_nop 1
    v_cvt_pk_bf16_f32 v132, 0, v132
    v_cvt_pk_bf16_f32 v133, 0, v133
    v_cvt_pk_bf16_f32 v134, 0, v134
    v_cvt_pk_bf16_f32 v135, 0, v135
    v_mul_f32 v164, 0xbfb8aa3b, v132
    v_mul_f32 v165, 0xbfb8aa3b, v133
    v_mul_f32 v166, 0xbfb8aa3b, v134
    v_mul_f32 v167, 0xbfb8aa3b, v135
    v_exp_f32 v164, v164
    v_exp_f32 v165, v165
    v_exp_f32 v166, v166
    v_exp_f32 v167, v167
    v_add_f32 v164, 1.0, v164
    v_add_f32 v165, 1.0, v165
    v_add_f32 v166, 1.0, v166
    v_add_f32 v167, 1.0, v167
    v_rcp_f32 v164, v164
    v_rcp_f32 v165, v165
    v_rcp_f32 v166, v166
    v_rcp_f32 v167, v167
    v_mul_f32 v164, v164, v132
    v_mul_f32 v165, v165, v133
    v_mul_f32 v166, v166, v134
    v_mul_f32 v167, v167, v135
    v_cvt_pk_bf16_f32 v156, v164, v165
    v_cvt_pk_bf16_f32 v157, v166, v167
    v_cvt_pk_bf16_f32 v136, 0, v136
    v_cvt_pk_bf16_f32 v137, 0, v137
    v_cvt_pk_bf16_f32 v138, 0, v138
    v_cvt_pk_bf16_f32 v139, 0, v139
    v_mul_f32 v164, 0xbfb8aa3b, v136
    v_mul_f32 v165, 0xbfb8aa3b, v137
    v_mul_f32 v166, 0xbfb8aa3b, v138
    v_mul_f32 v167, 0xbfb8aa3b, v139
    v_exp_f32 v164, v164
    v_exp_f32 v165, v165
    v_exp_f32 v166, v166
    v_exp_f32 v167, v167
    v_add_f32 v164, 1.0, v164
    v_add_f32 v165, 1.0, v165
    v_add_f32 v166, 1.0, v166
    v_add_f32 v167, 1.0, v167
    v_rcp_f32 v164, v164
    v_rcp_f32 v165, v165
    v_rcp_f32 v166, v166
    v_rcp_f32 v167, v167
    v_mul_f32 v164, v164, v136
    v_mul_f32 v165, v165, v137
    v_mul_f32 v166, v166, v138
    v_mul_f32 v167, v167, v139
    v_cvt_pk_bf16_f32 v158, v164, v165
    v_cvt_pk_bf16_f32 v159, v166, v167
    v_cvt_pk_bf16_f32 v140, 0, v140
    v_cvt_pk_bf16_f32 v141, 0, v141
    v_cvt_pk_bf16_f32 v142, 0, v142
    v_cvt_pk_bf16_f32 v143, 0, v143
    v_mul_f32 v164, 0xbfb8aa3b, v140
    v_mul_f32 v165, 0xbfb8aa3b, v141
    v_mul_f32 v166, 0xbfb8aa3b, v142
    v_mul_f32 v167, 0xbfb8aa3b, v143
    v_exp_f32 v164, v164
    v_exp_f32 v165, v165
    v_exp_f32 v166, v166
    v_exp_f32 v167, v167
    v_add_f32 v164, 1.0, v164
    v_add_f32 v165, 1.0, v165
    v_add_f32 v166, 1.0, v166
    v_add_f32 v167, 1.0, v167
    v_rcp_f32 v164, v164
    v_rcp_f32 v165, v165
    v_rcp_f32 v166, v166
    v_rcp_f32 v167, v167
    v_mul_f32 v164, v164, v140
    v_mul_f32 v165, v165, v141
    v_mul_f32 v166, v166, v142
    v_mul_f32 v167, v167, v143
    v_cvt_pk_bf16_f32 v160, v164, v165
    v_cvt_pk_bf16_f32 v161, v166, v167
    v_cvt_pk_bf16_f32 v144, 0, v144
    v_cvt_pk_bf16_f32 v145, 0, v145
    v_cvt_pk_bf16_f32 v146, 0, v146
    v_cvt_pk_bf16_f32 v147, 0, v147
    v_mul_f32 v164, 0xbfb8aa3b, v144
    v_mul_f32 v165, 0xbfb8aa3b, v145
    v_mul_f32 v166, 0xbfb8aa3b, v146
    v_mul_f32 v167, 0xbfb8aa3b, v147
    v_exp_f32 v164, v164
    v_exp_f32 v165, v165
    v_exp_f32 v166, v166
    v_exp_f32 v167, v167
    v_add_f32 v164, 1.0, v164
    v_add_f32 v165, 1.0, v165
    v_add_f32 v166, 1.0, v166
    v_add_f32 v167, 1.0, v167
    v_rcp_f32 v164, v164
    v_rcp_f32 v165, v165
    v_rcp_f32 v166, v166
    v_rcp_f32 v167, v167
    v_mul_f32 v164, v164, v144
    v_mul_f32 v165, v165, v145
    v_mul_f32 v166, v166, v146
    v_mul_f32 v167, v167, v147
    v_cvt_pk_bf16_f32 v162, v164, v165
    v_cvt_pk_bf16_f32 v163, v166, v167
    s_nop 1
L1_hdone:
    buffer_store_dwordx4 v[148:151], v65, s[76:79], 0 offen sc1
    buffer_store_dwordx4 v[152:155], v65, s[76:79], 0 offen offset:64 sc1
    v_add_u32 v65, 8192, v65
    buffer_store_dwordx4 v[156:159], v65, s[76:79], 0 offen sc1
    buffer_store_dwordx4 v[160:163], v65, s[76:79], 0 offen offset:64 sc1
    s_waitcnt vmcnt(8)
    s_nop 0
L1_consts:
    s_waitcnt lgkmcnt(0)
    s_add_u32 s100, s100, 1
    s_lshr_b32 s60, s100, 0
    s_lshl_b32 s61, s60, 24
    s_lshr_b32 s60, s60, 1
    s_and_b32 s60, s60, 0x180
    s_or_b32 s9, s60, s61
    s_lshr_b32 s60, s100, 10
    s_lshl_b32 s61, s60, 24
    s_lshr_b32 s60, s60, 1
    s_and_b32 s60, s60, 0x180
    s_or_b32 s10, s60, s61
    s_lshr_b32 s60, s100, 20
    s_lshl_b32 s61, s60, 24
    s_lshr_b32 s60, s60, 1
    s_and_b32 s60, s60, 0x180
    s_or_b32 s11, s60, s61
    s_xor_b32 s8, s9, 0xff000180
    s_mov_b32 s52, s16
    s_mov_b32 s53, s17
    s_mov_b32 s54, 24576
    s_mov_b32 s55, 0x20000
    s_mov_b32 s12, s18
    s_mov_b32 s13, s19
    s_mov_b32 s14, 1536
    s_mov_b32 s15, 0x20000
    v_mov_b32 v10, 0xffff0000
    v_lshrrev_b32 v43, 2, v0
    v_and_b32 v40, 0xf0, v43
    v_bfe_u32 v46, v43, 1, 3
    v_or_b32 v40, v40, v46
    v_and_b32 v46, 1, v43
    v_lshl_or_b32 v40, v46, 3, v40
    v_and_b32 v46, 3, v0
    v_lshlrev_b32 v178, 4, v46
    v_lshlrev_b32 v185, 2, v40
    v_add_u32 v185, 151552, v185
    v_mul_u32_u24 v40, 80, v40
    v_add_u32 v40, v40, v178
    v_add_u32 v172, 129024, v40
    v_lshlrev_b32 v173, 4, v0
    v_add_u32 v174, 8192, v173
    v_mov_b32 v175, 16776831
    v_mov_b32 v176, 16777215
    v_cmp_eq_u32 s[78:79], 0, v46
    v_add_u32 v186, 151552, v1
    s_nop 0
    v_cndmask_b32_e64 v176, v175, v176, s[78:79]
    v_not_b32 v180, v176
    v_and_b32 v177, s8, v180
    s_mov_b32 s60, 0x41c26666
    v_mul_u32_u24 v40, 5243, v56
    v_mul_u32_u24 v64, 6, v48
    v_lshrrev_b32 v40, 19, v40
    v_mul_u32_u24 v72, 6, v56
    v_mad_i32_i24 v41, v40, s84, v56
    v_lshl_add_u32 v80, v40, 2, s85
    v_lshl_or_b32 v96, v48, 9, v41
    v_mad_u32_u24 v88, v40, v47, s86
    v_and_b32 v48, -4, v64
    v_and_b32 v56, -4, v72
    v_mul_u32_u24 v40, 5243, v57
    v_mul_u32_u24 v65, 6, v49
    v_lshrrev_b32 v40, 19, v40
    v_mul_u32_u24 v73, 6, v57
    v_mad_i32_i24 v41, v40, s84, v57
    v_lshl_add_u32 v81, v40, 2, s85
    v_lshl_or_b32 v97, v49, 9, v41
    v_mad_u32_u24 v89, v40, v47, s86
    v_and_b32 v49, -4, v65
    v_and_b32 v57, -4, v73
    v_mul_u32_u24 v40, 5243, v58
    v_mul_u32_u24 v66, 6, v50
    v_lshrrev_b32 v40, 19, v40
    v_mul_u32_u24 v74, 6, v58
    v_mad_i32_i24 v41, v40, s84, v58
    v_lshl_add_u32 v82, v40, 2, s85
    v_lshl_or_b32 v98, v50, 9, v41
    v_mad_u32_u24 v90, v40, v47, s86
    v_and_b32 v50, -4, v66
    v_and_b32 v58, -4, v74
    v_mul_u32_u24 v40, 5243, v59
    v_mul_u32_u24 v67, 6, v51
    v_lshrrev_b32 v40, 19, v40
    v_mul_u32_u24 v75, 6, v59
    v_mad_i32_i24 v41, v40, s84, v59
    v_lshl_add_u32 v83, v40, 2, s85
    v_lshl_or_b32 v99, v51, 9, v41
    v_mad_u32_u24 v91, v40, v47, s86
    v_and_b32 v51, -4, v67
    v_and_b32 v59, -4, v75
    v_mul_u32_u24 v40, 5243, v60
    v_mul_u32_u24 v68, 6, v52
    v_lshrrev_b32 v40, 19, v40
    v_mul_u32_u24 v76, 6, v60
    v_mad_i32_i24 v41, v40, s84, v60
    v_lshl_add_u32 v84, v40, 2, s85
    v_lshl_or_b32 v100, v52, 9, v41
    v_mad_u32_u24 v92, v40, v47, s86
    v_and_b32 v52, -4, v68
    v_and_b32 v60, -4, v76
    v_mul_u32_u24 v40, 5243, v61
    v_mul_u32_u24 v69, 6, v53
    v_lshrrev_b32 v40, 19, v40
    v_mul_u32_u24 v77, 6, v61
    v_mad_i32_i24 v41, v40, s84, v61
    v_lshl_add_u32 v85, v40, 2, s85
    v_lshl_or_b32 v101, v53, 9, v41
    v_mad_u32_u24 v93, v40, v47, s86
    v_and_b32 v53, -4, v69
    v_and_b32 v61, -4, v77
    v_mul_u32_u24 v40, 5243, v62
    v_mul_u32_u24 v70, 6, v54
    v_lshrrev_b32 v40, 19, v40
    v_mul_u32_u24 v78, 6, v62
    v_mad_i32_i24 v41, v40, s84, v62
    v_lshl_add_u32 v86, v40, 2, s85
    v_lshl_or_b32 v102, v54, 9, v41
    v_mad_u32_u24 v94, v40, v47, s86
    v_and_b32 v54, -4, v70
    v_and_b32 v62, -4, v78
    s_mul_i32 s87, s2, 100
    v_lshrrev_b32 v41, 4, v1
    v_add_u32 v132, s87, v41
    v_add_u32 v133, 64, v132
    v_mul_u32_u24 v132, 6, v132
    v_and_b32 v134, -4, v132
    v_mul_u32_u24 v133, 6, v133
    v_and_b32 v135, -4, v133
    v_mov_b32 v46, 1
    s_setprio 0
    s_cmp_ge_u32 s3, 4
    s_cbranch_scc1 L1_b1
    s_waitcnt vmcnt(0)
L1_b1:
    s_waitcnt vmcnt(4) lgkmcnt(0)
    s_barrier
    ds_read2_b32 v[104:105], v48 offset1:1
    ds_read2_b32 v[106:107], v56 offset1:1
    ds_read2_b32 v[108:109], v49 offset1:1
    ds_read2_b32 v[110:111], v57 offset1:1
    ds_read2_b32 v[112:113], v50 offset1:1
    ds_read2_b32 v[114:115], v58 offset1:1
    ds_read2_b32 v[116:117], v51 offset1:1
    ds_read2_b32 v[118:119], v59 offset1:1
    ds_read2_b32 v[120:121], v52 offset1:1
    ds_read2_b32 v[122:123], v60 offset1:1
    ds_read2_b32 v[124:125], v53 offset1:1
    ds_read2_b32 v[126:127], v61 offset1:1
    s_lshl_b32 s84, s3, 12
    buffer_load_dwordx4 v[164:167], v1, s[44:47], s84 offen offset:0
    buffer_load_dwordx4 v[164:167], v1, s[44:47], s84 offen offset:1024
    buffer_load_dwordx4 v[164:167], v1, s[44:47], s84 offen offset:2048
    buffer_load_dwordx4 v[164:167], v1, s[44:47], s84 offen offset:3072
    s_mov_b64 s[76:77], 0
    s_sub_u32 s84, s3, 2
    s_cmp_lt_u32 s84, 2
    s_cbranch_scc0 L1_six
    s_waitcnt lgkmcnt(10)
    v_alignbyte_b32 v40, v105, v104, v64
    v_alignbyte_b32 v41, v105, v105, v64
    v_alignbyte_b32 v42, v107, v106, v72
    v_alignbyte_b32 v43, v107, v107, v72
    v_lshlrev_b32 v104, 16, v40
    v_lshlrev_b32 v106, 16, v42
    v_and_b32 v40, v10, v40
    v_and_b32 v42, v10, v42
    v_lshlrev_b32 v41, 16, v41
    v_lshlrev_b32 v43, 16, v43
    v_sub_f32 v104, v104, v106
    v_sub_f32 v40, v40, v42
    v_sub_f32 v41, v41, v43
    v_mul_f32 v104, v104, v104
    v_fmac_f32 v104, v40, v40
    v_fmac_f32 v104, v41, v41
    v_cmp_ngt_f32 s[64:65], v104, s60
    ds_read2_b32 v[128:129], v54 offset1:1
    ds_read2_b32 v[130:131], v62 offset1:1
    s_waitcnt lgkmcnt(0)
    v_alignbyte_b32 v40, v129, v128, v70
    v_alignbyte_b32 v41, v129, v129, v70
    v_alignbyte_b32 v42, v131, v130, v78
    v_alignbyte_b32 v43, v131, v131, v78
    v_lshlrev_b32 v128, 16, v40
    v_lshlrev_b32 v130, 16, v42
    v_and_b32 v40, v10, v40
    v_and_b32 v42, v10, v42
    v_lshlrev_b32 v41, 16, v41
    v_lshlrev_b32 v43, 16, v43
    v_sub_f32 v128, v128, v130
    v_sub_f32 v40, v40, v42
    v_sub_f32 v41, v41, v43
    v_mul_f32 v128, v128, v128
    v_fmac_f32 v128, v40, v40
    v_fmac_f32 v128, v41, v41
    v_cmp_ngt_f32 s[76:77], v128, s60
    s_nop 4
    s_branch L1_rest
L1_six:
    s_cmp_lg_u32 s3, 7
    s_cbranch_scc1 L1_notw7
    s_waitcnt lgkmcnt(8)
    ds_read2_b32 v[152:153], v134 offset1:1
    ds_read2_b32 v[154:155], v135 offset1:1
    s_waitcnt lgkmcnt(0)
    v_alignbyte_b32 v156, v153, v152, v132
    v_alignbyte_b32 v157, v153, v153, v132
    v_lshlrev_b32 v144, 16, v156
    v_and_b32 v145, v10, v156
    v_lshlrev_b32 v146, 16, v157
    v_mov_b32 v147, 0
    v_alignbyte_b32 v158, v155, v154, v133
    v_alignbyte_b32 v159, v155, v155, v133
    v_lshlrev_b32 v148, 16, v158
    v_and_b32 v149, v10, v158
    v_lshlrev_b32 v150, 16, v159
    v_mov_b32 v151, 0
    s_nop 1
L1_notw7:
    s_waitcnt lgkmcnt(10)
    v_alignbyte_b32 v40, v105, v104, v64
    v_alignbyte_b32 v41, v105, v105, v64
    v_alignbyte_b32 v42, v107, v106, v72
    v_alignbyte_b32 v43, v107, v107, v72
    v_lshlrev_b32 v104, 16, v40
    v_lshlrev_b32 v106, 16, v42
    v_and_b32 v40, v10, v40
    v_and_b32 v42, v10, v42
    v_lshlrev_b32 v41, 16, v41
    v_lshlrev_b32 v43, 16, v43
    v_sub_f32 v104, v104, v106
    v_sub_f32 v40, v40, v42
    v_sub_f32 v41, v41, v43
    v_mul_f32 v104, v104, v104
    v_fmac_f32 v104, v40, v40
    v_fmac_f32 v104, v41, v41
    v_cmp_ngt_f32 s[64:65], v104, s60
    s_nop 4
L1_rest:
    s_waitcnt lgkmcnt(8)
    v_alignbyte_b32 v40, v109, v108, v65
    v_alignbyte_b32 v41, v109, v109, v65
    v_alignbyte_b32 v42, v111, v110, v73
    v_alignbyte_b32 v43, v111, v111, v73
    v_lshlrev_b32 v108, 16, v40
    v_lshlrev_b32 v110, 16, v42
    v_and_b32 v40, v10, v40
    v_and_b32 v42, v10, v42
    v_lshlrev_b32 v41, 16, v41
    v_lshlrev_b32 v43, 16, v43
    v_sub_f32 v108, v108, v110
    v_sub_f32 v40, v40, v42
    v_sub_f32 v41, v41, v43
    v_mul_f32 v108, v108, v108
    v_fmac_f32 v108, v40, v40
    v_fmac_f32 v108, v41, v41
    v_cmp_ngt_f32 s[66:67], v108, s60
    s_waitcnt lgkmcnt(6)
    v_alignbyte_b32 v40, v113, v112, v66
    v_alignbyte_b32 v41, v113, v113, v66
    v_alignbyte_b32 v42, v115, v114, v74
    v_alignbyte_b32 v43, v115, v115, v74
    v_lshlrev_b32 v112, 16, v40
    v_lshlrev_b32 v114, 16, v42
    v_and_b32 v40, v10, v40
    v_and_b32 v42, v10, v42
    v_lshlrev_b32 v41, 16, v41
    v_lshlrev_b32 v43, 16, v43
    v_sub_f32 v112, v112, v114
    v_sub_f32 v40, v40, v42
    v_sub_f32 v41, v41, v43
    v_mul_f32 v112, v112, v112
    v_fmac_f32 v112, v40, v40
    v_fmac_f32 v112, v41, v41
    v_cmp_ngt_f32 s[68:69], v112, s60
    s_waitcnt lgkmcnt(4)
    v_alignbyte_b32 v40, v117, v116, v67
    v_alignbyte_b32 v41, v117, v117, v67
    v_alignbyte_b32 v42, v119, v118, v75
    v_alignbyte_b32 v43, v119, v119, v75
    v_lshlrev_b32 v116, 16, v40
    v_lshlrev_b32 v118, 16, v42
    v_and_b32 v40, v10, v40
    v_and_b32 v42, v10, v42
    v_lshlrev_b32 v41, 16, v41
    v_lshlrev_b32 v43, 16, v43
    v_sub_f32 v116, v116, v118
    v_sub_f32 v40, v40, v42
    v_sub_f32 v41, v41, v43
    v_mul_f32 v116, v116, v116
    v_fmac_f32 v116, v40, v40
    v_fmac_f32 v116, v41, v41
    v_cmp_ngt_f32 s[70:71], v116, s60
    s_waitcnt lgkmcnt(2)
    v_alignbyte_b32 v40, v121, v120, v68
    v_alignbyte_b32 v41, v121, v121, v68
    v_alignbyte_b32 v42, v123, v122, v76
    v_alignbyte_b32 v43, v123, v123, v76
    v_lshlrev_b32 v120, 16, v40
    v_lshlrev_b32 v122, 16, v42
    v_and_b32 v40, v10, v40
    v_and_b32 v42, v10, v42
    v_lshlrev_b32 v41, 16, v41
    v_lshlrev_b32 v43, 16, v43
    v_sub_f32 v120, v120, v122
    v_sub_f32 v40, v40, v42
    v_sub_f32 v41, v41, v43
    v_mul_f32 v120, v120, v120
    v_fmac_f32 v120, v40, v40
    v_fmac_f32 v120, v41, v41
    v_cmp_ngt_f32 s[72:73], v120, s60
    s_waitcnt lgkmcnt(0)
    v_alignbyte_b32 v40, v125, v124, v69
    v_alignbyte_b32 v41, v125, v125, v69
    v_alignbyte_b32 v42, v127, v126, v77
    v_alignbyte_b32 v43, v127, v127, v77
    v_lshlrev_b32 v124, 16, v40
    v_lshlrev_b32 v126, 16, v42
    v_and_b32 v40, v10, v40
    v_and_b32 v42, v10, v42
    v_lshlrev_b32 v41, 16, v41
    v_lshlrev_b32 v43, 16, v43
    v_sub_f32 v124, v124, v126
    v_sub_f32 v40, v40, v42
    v_sub_f32 v41, v41, v43
    v_mul_f32 v124, v124, v124
    v_fmac_f32 v124, v40, v40
    v_fmac_f32 v124, v41, v41
    v_cmp_ngt_f32 s[74:75], v124, s60
    s_mov_b64 exec, s[76:77]
    ds_add_rtn_u32 v142, v86, v46
    s_mov_b64 exec, s[64:65]
    ds_add_rtn_u32 v136, v80, v46
    s_mov_b64 exec, s[66:67]
    ds_add_rtn_u32 v137, v81, v46
    s_mov_b64 exec, s[68:69]
    ds_add_rtn_u32 v138, v82, v46
    s_mov_b64 exec, s[70:71]
    ds_add_rtn_u32 v139, v83, v46
    s_mov_b64 exec, s[72:73]
    ds_add_rtn_u32 v140, v84, v46
    s_mov_b64 exec, s[74:75]
    ds_add_rtn_u32 v141, v85, v46
    s_mov_b64 exec, -1
    s_waitcnt lgkmcnt(0)
    s_barrier
    s_mul_i32 s89, s3, 3072
    s_add_u32 m0, s89, 101376
    s_lshl_b32 s90, s3, 10
    s_min_u32 s91, s90, 2048
    buffer_load_dwordx4 v1, s[52:55], s89 offen offset:0 lds
    buffer_load_dwordx4 v1, s[52:55], s89 offen offset:1024 lds
    buffer_load_dwordx4 v1, s[52:55], s89 offen offset:2048 lds
    s_add_u32 m0, s91, 125952
    ds_read_b128 v[104:107], v186
    buffer_load_dwordx4 v1, s[12:15], s90 offen lds
    ds_read_b32 v108, v185
    ds_read_b32 v109, v185 offset:512
    v_min_u32 v40, 15, v136
    v_lshl_add_u32 v88, v40, 2, v88
    v_min_u32 v40, 15, v137
    v_lshl_add_u32 v89, v40, 2, v89
    v_min_u32 v40, 15, v138
    v_lshl_add_u32 v90, v40, 2, v90
    v_min_u32 v40, 15, v139
    v_lshl_add_u32 v91, v40, 2, v91
    v_min_u32 v40, 15, v140
    v_lshl_add_u32 v92, v40, 2, v92
    v_min_u32 v40, 15, v141
    v_lshl_add_u32 v93, v40, 2, v93
    v_min_u32 v40, 15, v142
    v_lshl_add_u32 v94, v40, 2, v94
    s_mov_b64 exec, s[64:65]
    ds_write_b32 v88, v96 offset:4
    s_mov_b64 exec, s[66:67]
    ds_write_b32 v89, v97 offset:4
    s_mov_b64 exec, s[68:69]
    ds_write_b32 v90, v98 offset:4
    s_mov_b64 exec, s[70:71]
    ds_write_b32 v91, v99 offset:4
    s_mov_b64 exec, s[72:73]
    ds_write_b32 v92, v100 offset:4
    s_mov_b64 exec, s[74:75]
    ds_write_b32 v93, v101 offset:4
    s_mov_b64 exec, s[76:77]
    ds_write_b32 v94, v102 offset:4
    s_mov_b64 exec, -1
    s_cmp_ge_u32 s3, 2
    s_cbranch_scc1 L2_nozeroa
    v_lshlrev_b32 v42, 2, v0
    v_mov_b32 v44, 0
    ds_write_b32 v42, v44 offset:24576
L2_nozeroa:
    s_cmp_lg_u32 s3, 7
    s_cbranch_scc1 L1_join
    ds_write_b128 v1, v[144:147] offset:25600
    ds_write_b128 v1, v[148:151] offset:26624
L1_join:
    s_mul_i32 s86, s2, 16512
    s_add_u32 s86, s86, 4194304
    s_add_u32 s84, s24, s86
    s_addc_u32 s85, s25, 0
    s_mov_b32 s86, 16384
    s_mov_b32 s87, 0x20000
    s_waitcnt vmcnt(8) lgkmcnt(0)
    v_max3_u32 v104, v104, v105, v106
    v_max_u32 v104, v104, v107
    v_cmp_lt_u32 vcc, 15, v104
    s_barrier
    ds_read_b128 v[48:51], v172
    ds_read_b128 v[52:55], v172 offset:10240
    s_cbranch_vccnz L1_ovf
L1_noovf:
    s_waitcnt lgkmcnt(1)
    v_cndmask_b32_e64 v48, v48, v108, s[78:79]
    v_and_or_b32 v49, v49, v175, s9
    v_and_or_b32 v50, v50, v175, s10
    v_and_or_b32 v51, v51, v175, s11
    v_and_or_b32 v48, v48, v176, v177
    buffer_store_dwordx4 v[48:51], v173, s[84:87], 0 offen sc1
    s_waitcnt lgkmcnt(0)
    v_cndmask_b32_e64 v52, v52, v109, s[78:79]
    v_and_or_b32 v53, v53, v175, s9
    v_and_or_b32 v54, v54, v175, s10
    v_and_or_b32 v55, v55, v175, s11
    v_and_or_b32 v52, v52, v176, v177
    buffer_store_dwordx4 v[52:55], v174, s[84:87], 0 offen sc1
    s_and_b32 s60, s2, 0xf0
    s_and_b32 s61, s2, 7
    s_lshl_b32 s61, s61, 1
    s_or_b32 s60, s60, s61
    s_bfe_u32 s61, s2, 0x10003
    s_or_b32 s60, s60, s61
    s_lshl_b32 s60, s60, 6
    s_add_u32 s60, s60, 4194304
    s_add_u32 s48, s24, s60
    s_addc_u32 s49, s25, 0
    s_mov_b32 s50, 4111552
    s_mov_b32 s51, 0x20000
    v_lshrrev_b32 v43, 2, v0
    v_mul_u32_u24 v43, 16512, v43
    v_add_u32 v178, v178, v43
    v_add_u32 v179, 2113536, v178
    v_not_b32 v181, v175
    v_cmp_gt_u32 vcc, 488, v0
    s_nop 0
    s_mov_b64 s[64:65], vcc
    s_mov_b32 s61, 65536
    s_waitcnt vmcnt(2)
    s_barrier
    s_and_b32 s59, s57, 0xffff0000
    s_lshl_b32 s58, s57, 16
    s_and_b32 s57, s56, 0xffff0000
    s_lshl_b32 s56, s56, 16
    s_mov_b32 s28, s4
    s_mov_b32 s29, s5
    s_mov_b32 s30, 12800000
    s_mov_b32 s31, 0x20000
    s_mov_b32 s32, s24
    s_mov_b32 s33, s25
    s_mov_b32 s34, 3200000
    s_mov_b32 s35, 0x20000
    s_mul_i32 s42, s2, 51200
    s_add_u32 s40, s20, s42
    s_addc_u32 s41, s21, 0
    s_mov_b32 s42, 51200
    s_mov_b32 s43, 0x20000
    s_add_u32 s80, s24, 8388608
    s_addc_u32 s81, s25, 0
    s_mov_b32 s82, 3200000
    s_mov_b32 s83, 0x20000
    v_bfe_u32 v44, v1, 4, 4
    v_lshrrev_b32 v45, 8, v1
    v_lshrrev_b32 v43, 2, v44
    v_lshlrev_b32 v43, 3, v43
    v_and_b32 v40, 3, v44
    v_add_u32 v43, v43, v40
    s_mul_i32 s6, s3, 768
    s_add_u32 s6, s6, 27680
    s_sub_u32 s7, 33824, s6
    v_lshl_add_u32 v14, v43, 2, s6
    v_and_b32 v40, 1, v45
    v_lshl_add_u32 v43, v40, 2, v43
    v_lshrrev_b32 v40, 1, v45
    v_lshl_add_u32 v43, v40, 5, v43
    v_lshl_add_u32 v2, v43, 2, s6
    v_lshl_add_u32 v3, v43, 1, s6
    v_lshl_add_u32 v4, v45, 5, s6
    v_lshl_add_u32 v5, v45, 4, s6
    v_lshrrev_b32 v6, 2, v44
    v_lshlrev_b32 v6, 1, v6
    v_and_b32 v40, 1, v44
    v_add_u32 v6, v6, v40
    v_and_b32 v40, 2, v44
    v_lshl_add_u32 v6, v40, 2, v6
    v_lshlrev_b32 v6, 3, v6
    v_lshl_add_u32 v8, v44, 9, v7
    v_lshl_or_b32 v9, v44, 16, v44
    s_mov_b32 s88, 0
    v_lshrrev_b32 v40, 1, v45
    v_add_u32 v188, 0, v40
    v_lshlrev_b32 v188, 5, v188
    v_xor_b32 v188, v188, v1
    v_add_u32 v189, 2, v40
    v_lshlrev_b32 v189, 5, v189
    v_xor_b32 v189, v189, v1
    v_add_u32 v190, 4, v40
    v_lshlrev_b32 v190, 5, v190
    v_xor_b32 v190, v190, v1
    v_add_u32 v191, 6, v40
    v_lshlrev_b32 v191, 5, v191
    v_xor_b32 v191, v191, v1
    v_and_b32 v39, 3, v0
    v_lshlrev_b32 v39, 2, v39
    v_subrev_u32 v39, 1, v39
    s_and_b32 s60, s3, 1
    s_mul_i32 s60, s60, 12288
    s_bfe_u32 s62, s3, 0x20001
    s_lshl_b32 s62, s62, 1
    s_add_u32 s60, s60, s62
    s_add_u32 s60, s60, 101376
    v_mul_u32_u24 v182, 96, v7
    v_add3_u32 v182, v182, v6, s60
    s_lshl_b32 s60, s3, 10
    v_add_u32 v183, s60, v1
    v_lshrrev_b32 v184, 3, v7
    v_add_u32 v184, v184, v6
    v_add_u32 v184, 125952, v184
    ds_read_u16 v104, v184 offset:0
    ds_read_u16 v105, v184 offset:384
    ds_read_u16 v106, v184 offset:768
    ds_read_u16 v107, v184 offset:1152
    ds_read_u16 v108, v184 offset:128
    ds_read_u16 v109, v184 offset:512
    ds_read_u16 v110, v184 offset:896
    ds_read_u16 v111, v184 offset:1280
    ds_read_u16 v112, v184 offset:256
    ds_read_u16 v113, v184 offset:640
    ds_read_u16 v114, v184 offset:1024
    ds_read_u16 v115, v184 offset:1408
    s_waitcnt lgkmcnt(0)
    ds_read_u16 v64, v182 offset:0
    ds_read_u16 v65, v182 offset:384
    ds_read_u16 v66, v182 offset:768
    ds_read_u16 v67, v182 offset:1152
    ds_read_u16 v68, v182 offset:6144
    ds_read_u16 v69, v182 offset:6528
    ds_read_u16 v70, v182 offset:6912
    ds_read_u16 v71, v182 offset:7296
    v_lshl_or_b32 v24, v105, 16, v104
    v_lshl_or_b32 v25, v107, 16, v106
    v_lshl_or_b32 v26, v109, 16, v108
    v_lshl_or_b32 v27, v111, 16, v110
    v_lshl_or_b32 v28, v113, 16, v112
    v_lshl_or_b32 v29, v115, 16, v114
    ds_read_u16 v72, v182 offset:128
    ds_read_u16 v73, v182 offset:512
    ds_read_u16 v74, v182 offset:896
    ds_read_u16 v75, v182 offset:1280
    ds_read_u16 v76, v182 offset:6272
    s_waitcnt lgkmcnt(11)
    ds_read_u16 v77, v182 offset:6656
    ds_read_u16 v78, v182 offset:7040
    ds_read_u16 v79, v182 offset:7424
    s_waitcnt lgkmcnt(8)
    v_lshl_or_b32 v80, v65, 16, v64
    v_lshl_or_b32 v81, v67, 16, v66
    v_lshl_or_b32 v82, v69, 16, v68
    v_lshl_or_b32 v83, v71, 16, v70
    ds_write_b128 v183, v[80:83] offset:0
    ds_read_u16 v64, v182 offset:256
    ds_read_u16 v65, v182 offset:640
    ds_read_u16 v66, v182 offset:1024
    ds_read_u16 v67, v182 offset:1408
    ds_read_u16 v68, v182 offset:6400
    s_waitcnt lgkmcnt(11)
    ds_read_u16 v69, v182 offset:6784
    ds_read_u16 v70, v182 offset:7168
    ds_read_u16 v71, v182 offset:7552
    s_waitcnt lgkmcnt(8)
    v_lshl_or_b32 v80, v73, 16, v72
    v_lshl_or_b32 v81, v75, 16, v74
    v_lshl_or_b32 v82, v77, 16, v76
    v_lshl_or_b32 v83, v79, 16, v78
    ds_write_b128 v183, v[80:83] offset:8192
    s_waitcnt lgkmcnt(1)
    v_lshl_or_b32 v84, v65, 16, v64
    v_lshl_or_b32 v85, v67, 16, v66
    v_lshl_or_b32 v86, v69, 16, v68
    v_lshl_or_b32 v87, v71, 16, v70
    ds_write_b128 v183, v[84:87] offset:16384
    s_nop 1
    buffer_load_dwordx4 v[48:51], v178, s[48:51], 0 offen sc1
    buffer_load_dwordx4 v[52:55], v179, s[48:51], 0 offen sc1
    s_waitcnt vmcnt(0)
L2_poll:
    v_xor_b32 v61, v177, v48
    v_and_b32 v61, v180, v61
    v_xor_b32 v63, s9, v49
    v_and_or_b32 v61, v63, v181, v61
    v_xor_b32 v63, s10, v50
    v_and_or_b32 v61, v63, v181, v61
    v_xor_b32 v63, s11, v51
    v_and_or_b32 v61, v63, v181, v61
    v_xor_b32 v62, v177, v52
    v_and_b32 v62, v180, v62
    v_xor_b32 v63, s9, v53
    v_and_or_b32 v62, v63, v181, v62
    v_xor_b32 v63, s10, v54
    v_and_or_b32 v62, v63, v181, v62
    v_xor_b32 v63, s11, v55
    v_and_or_b32 v62, v63, v181, v62
    v_cmp_ne_u32 vcc, 0, v61
    v_cmp_ne_u32 s[66:67], 0, v62
    s_nop 0
    s_and_b64 s[66:67], s[66:67], s[64:65]
    s_or_b64 s[68:69], s[66:67], vcc
    s_nop 1
    s_cbranch_scc0 L2_polled
    s_sub_u32 s61, s61, 1
    s_cmp_eq_u32 s61, 0
    s_cbranch_scc1 L2_polled
    s_mov_b64 exec, vcc
    s_cbranch_execz L2_nopollA
    buffer_load_dwordx4 v[48:51], v178, s[48:51], 0 offen sc1
L2_nopollA:
    s_mov_b64 exec, s[66:67]
    s_cbranch_execz L2_nopollB
    buffer_load_dwordx4 v[52:55], v179, s[48:51], 0 offen sc1
L2_nopollB:
    s_mov_b64 exec, -1
    s_waitcnt vmcnt(0)
    s_branch L2_poll
L2_polled:
    s_lshl_b32 s89, s3, 12
    s_add_u32 m0, s89, 50176
    s_cmp_ge_u32 s3, 5
    buffer_load_dwordx4 v188, s[44:47], s89 offen offset:0 sc1 lds
    buffer_load_dwordx4 v189, s[44:47], s89 offen offset:1024 sc1 lds
    buffer_load_dwordx4 v190, s[44:47], s89 offen offset:2048 sc1 lds
    buffer_load_dwordx4 v191, s[44:47], s89 offen offset:3072 sc1 lds
    s_cbranch_scc1 L2_resdonea
    s_add_u32 s89, s89, 32768
    s_add_u32 m0, s89, 50176
    s_cmp_eq_u32 s3, 4
    buffer_load_dwordx4 v188, s[44:47], s89 offen offset:0 sc1 lds
    buffer_load_dwordx4 v189, s[44:47], s89 offen offset:1024 sc1 lds
    s_cbranch_scc1 L2_resdonea
    buffer_load_dwordx4 v190, s[44:47], s89 offen offset:2048 sc1 lds
    buffer_load_dwordx4 v191, s[44:47], s89 offen offset:3072 sc1 lds
L2_resdonea:
    v_mov_b32_dpp v58, v48 quad_perm:[0,0,0,0] row_mask:0xf bank_mask:0xf
    v_mov_b32_dpp v59, v52 quad_perm:[0,0,0,0] row_mask:0xf bank_mask:0xf
    v_and_b32 v58, 0xfff, v58
    v_min_u32 v56, 15, v58
    v_subrev_u32 v58, 15, v58
    v_and_b32 v59, 0xfff, v59
    v_min_u32 v57, 15, v59
    v_subrev_u32 v59, 15, v59
    s_nop 1
L2_round:
    v_mov_b32 v40, 1
    s_mov_b32 s60, 24576
    v_add_u32 v41, 0, v39
    v_add_u32 v42, 1, v39
    v_add_u32 v43, 2, v39
    v_add_u32 v44, 3, v39
    v_cmp_lt_u32 s[64:65], v41, v56
    v_and_b32 v60, 127, v48
    v_lshl_add_u32 v60, v60, 2, s60
    v_cmp_lt_u32 s[66:67], v42, v56
    v_and_b32 v61, 127, v49
    v_lshl_add_u32 v61, v61, 2, s60
    v_cmp_lt_u32 s[68:69], v43, v56
    v_and_b32 v62, 127, v50
    v_lshl_add_u32 v62, v62, 2, s60
    v_cmp_lt_u32 s[70:71], v44, v56
    v_and_b32 v63, 127, v51
    v_lshl_add_u32 v63, v63, 2, s60
    v_cmp_lt_u32 s[72:73], v41, v57
    v_and_b32 v64, 127, v52
    v_lshl_add_u32 v64, v64, 2, s60
    v_cmp_lt_u32 s[74:75], v42, v57
    v_and_b32 v65, 127, v53
    v_lshl_add_u32 v65, v65, 2, s60
    v_cmp_lt_u32 s[76:77], v43, v57
    v_and_b32 v66, 127, v54
    v_lshl_add_u32 v66, v66, 2, s60
    v_cmp_lt_u32 s[78:79], v44, v57
    v_and_b32 v67, 127, v55
    v_lshl_add_u32 v67, v67, 2, s60
    v_max_i32 v41, v58, v59
    v_cmp_lt_i32 vcc, 0, v41
    s_mov_b64 exec, s[64:65]
    ds_add_rtn_u32 v68, v60, v40
    s_mov_b64 exec, s[66:67]
    ds_add_rtn_u32 v69, v61, v40
    s_mov_b64 exec, s[68:69]
    ds_add_rtn_u32 v70, v62, v40
    s_mov_b64 exec, s[70:71]
    ds_add_rtn_u32 v71, v63, v40
    s_mov_b64 exec, s[72:73]
    ds_add_rtn_u32 v72, v64, v40
    s_mov_b64 exec, s[74:75]
    ds_add_rtn_u32 v73, v65, v40
    s_mov_b64 exec, s[76:77]
    ds_add_rtn_u32 v74, v66, v40
    s_mov_b64 exec, s[78:79]
    ds_add_rtn_u32 v75, v67, v40
    s_mov_b64 exec, -1
    s_cbranch_vccz L2_noflag
    v_mov_b32 v41, 25084
    ds_write_b32 v41, v40
L2_noflag:
    v_and_b32 v48, 16776831, v48
    v_and_b32 v49, 16776831, v49
    v_and_b32 v50, 16776831, v50
    v_and_b32 v51, 16776831, v51
    v_and_b32 v52, 16776831, v52
    v_and_b32 v53, 16776831, v53
    v_and_b32 v54, 16776831, v54
    v_and_b32 v55, 16776831, v55
    s_waitcnt lgkmcnt(0)
    s_barrier
    s_cmp_lg_u32 s88, 0
    s_cbranch_scc1 L2_now2f
    s_or_b32 s60, s2, s3
    s_cmp_lg_u32 s60, 0
    s_cbranch_scc1 L2_now2f
    s_add_u32 s84, s24, 8322304
    s_addc_u32 s85, s25, 0
    s_mov_b32 s86, 4
    s_mov_b32 s87, 0x20000
    v_mov_b32 v43, s100
    s_mov_b64 exec, 1
    buffer_store_dword v43, off, s[84:87], 0 sc1
    s_mov_b64 exec, -1
L2_now2f:
    v_lshrrev_b32 v41, 2, v1
    v_add_u32 v41, 24576, v41
    ds_read2st64_b32 v[42:43], v41 offset1:1
    s_waitcnt lgkmcnt(0)
    v_readlane_b32 s87, v43, 63
    v_lshl_or_b32 v42, v43, 16, v42
    v_mov_b32 v43, v42
    s_nop 1
    v_add_u32_dpp v43, v43, v43 row_shr:1 row_mask:0xf bank_mask:0xf
    s_nop 1
    v_add_u32_dpp v43, v43, v43 row_shr:2 row_mask:0xf bank_mask:0xf
    s_nop 1
    v_add_u32_dpp v43, v43, v43 row_shr:4 row_mask:0xf bank_mask:0xf
    s_nop 1
    v_add_u32_dpp v43, v43, v43 row_shr:8 row_mask:0xf bank_mask:0xf
    s_nop 1
    v_add_u32_dpp v43, v43, v43 row_bcast:15 row_mask:0xa bank_mask:0xf
    s_nop 1
    v_add_u32_dpp v43, v43, v43 row_bcast:31 row_mask:0xc bank_mask:0xf
    s_nop 0
    v_readlane_b32 s89, v43, 63
    v_sub_u32 v43, v43, v42
    s_and_b32 s89, s89, 0xffff
    v_and_b32 v112, 0xffff, v43
    v_lshrrev_b32 v113, 16, v43
    v_add_u32 v113, s89, v113
    ds_write2st64_b32 v41, v112, v113 offset0:2 offset1:3
    ds_read_b32 v76, v60 offset:512
    ds_read_b32 v77, v61 offset:512
    ds_read_b32 v78, v62 offset:512
    ds_read_b32 v79, v63 offset:512
    ds_read_b32 v80, v64 offset:512
    ds_read_b32 v81, v65 offset:512
    ds_read_b32 v82, v66 offset:512
    ds_read_b32 v83, v67 offset:512
    v_lshl_or_b32 v12, v113, 16, v112
    s_waitcnt lgkmcnt(4)
    v_add_lshl_u32 v76, v76, v68, 2
    v_add_lshl_u32 v77, v77, v69, 2
    v_add_lshl_u32 v78, v78, v70, 2
    v_add_lshl_u32 v79, v79, v71, 2
    s_mov_b64 exec, s[64:65]
    ds_write_b32 v76, v48 offset:33824
    s_mov_b64 exec, s[66:67]
    ds_write_b32 v77, v49 offset:33824
    s_mov_b64 exec, s[68:69]
    ds_write_b32 v78, v50 offset:33824
    s_mov_b64 exec, s[70:71]
    ds_write_b32 v79, v51 offset:33824
    s_mov_b64 exec, -1
    s_waitcnt lgkmcnt(0)
    v_add_lshl_u32 v80, v80, v72, 2
    v_add_lshl_u32 v81, v81, v73, 2
    v_add_lshl_u32 v82, v82, v74, 2
    v_add_lshl_u32 v83, v83, v75, 2
    s_mov_b64 exec, s[72:73]
    ds_write_b32 v80, v52 offset:33824
    s_mov_b64 exec, s[74:75]
    ds_write_b32 v81, v53 offset:33824
    s_mov_b64 exec, s[76:77]
    ds_write_b32 v82, v54 offset:33824
    s_mov_b64 exec, s[78:79]
    ds_write_b32 v83, v55 offset:33824
    s_mov_b64 exec, -1
    v_add_u32 v76, 32, v112
    v_lshlrev_b32 v80, 2, v76
    v_add_u32 v77, 32, v113
    v_lshlrev_b32 v81, 2, v77
    v_add_u32 v78, 64, v112
    v_lshlrev_b32 v82, 2, v78
    v_add_u32 v79, 64, v113
    v_lshlrev_b32 v83, 2, v79
    v_readlane_b32 s91, v113, 36
    v_lshrrev_b32 v40, 4, v1
    v_add_u32 v41, 64, v40
    v_mov_b32 v46, 100
    s_mov_b32 s60, 0
    s_mov_b32 s61, s3
    s_waitcnt vmcnt(0) lgkmcnt(0)
    s_barrier
    ds_read_b32 v82, v82 offset:33824
    ds_read_b32 v83, v83 offset:33824
    ds_read_b32 v80, v80 offset:33824
    ds_read_b32 v81, v81 offset:33824
    v_cmp_gt_u32 s[64:65], s91, v76
    v_cmp_gt_u32 s[66:67], s91, v77
    v_cmp_gt_u32 s[68:69], s91, v78
    v_cmp_gt_u32 s[70:71], s91, v79
    v_add_u32 v42, 1, v40
    v_add_u32 v43, 16, v40
    v_add_u32 v44, 1, v41
    v_add_u32 v45, 16, v41
    s_waitcnt lgkmcnt(2)
    v_and_b32 v82, 127, v82
    v_cndmask_b32_e64 v82, v46, v82, s[68:69]
    v_med3_u32 v82, v82, v42, v43
    v_min_u32 v82, v46, v82
    v_and_b32 v83, 127, v83
    v_cndmask_b32_e64 v83, v46, v83, s[70:71]
    v_med3_u32 v83, v83, v44, v45
    v_min_u32 v83, v46, v83
    v_lshl_or_b32 v13, v83, 16, v82
    s_waitcnt lgkmcnt(0)
    v_and_b32 v80, 127, v80
    v_cndmask_b32_e64 v80, v46, v80, s[64:65]
    v_med3_u32 v80, v80, v42, v43
    v_min_u32 v80, v46, v80
    v_and_b32 v81, 127, v81
    v_cndmask_b32_e64 v81, v46, v81, s[66:67]
    v_med3_u32 v81, v81, v44, v45
    v_min_u32 v81, v46, v81
    v_lshl_or_b32 v18, v81, 16, v80
    s_cmp_eq_u32 s61, 0
    s_cbranch_scc1 L2_walkdone0
L2_walk0:
    v_readlane_b32 s89, v13, s60
    s_lshr_b32 s90, s60, 2
    s_and_b32 s90, s90, 16
    s_lshr_b32 s89, s89, s90
    s_and_b32 s60, s89, 0xffff
    s_sub_u32 s61, s61, 1
    s_cmp_lg_u32 s61, 0
    s_cbranch_scc1 L2_walk0
L2_walkdone0:
    s_cmp_lt_u32 s60, 100
    s_cbranch_scc0 L2_rounddone
    s_setprio 3
    s_mov_b32 s63, s60
    v_readlane_b32 s89, v12, s60
    s_lshr_b32 s90, s60, 2
    s_and_b32 s90, s90, 16
    s_lshr_b32 s89, s89, s90
    s_and_b32 s84, s89, 0xffff
    v_readlane_b32 s89, v13, s60
    s_lshr_b32 s90, s60, 2
    s_and_b32 s90, s90, 16
    s_lshr_b32 s89, s89, s90
    s_and_b32 s60, s89, 0xffff
    v_readlane_b32 s89, v12, s60
    s_lshr_b32 s90, s60, 2
    s_and_b32 s90, s90, 16
    s_lshr_b32 s89, s89, s90
    s_and_b32 s85, s89, 0xffff
    s_sub_u32 s61, 7, s3
    s_min_u32 s62, s3, 4
    s_sub_u32 s74, s3, s62
    s_mov_b32 s75, 0
    s_lshr_b32 s76, s3, 2
    s_mov_b32 s77, s76
    s_mov_b32 s78, 0
    s_mov_b32 s79, s91
L2_issue:
    s_sub_u32 s26, s60, s63
    s_mov_b32 s70, s84
    s_mov_b32 s71, s85
    s_lshl_b32 s89, s70, 2
    v_lshrrev_b32 v249, 2, v1
    v_add_u32 v248, s89, v249
    ds_read_b32 v17, v248 offset:33824
    s_sub_u32 s89, s71, s70
    s_lshl_b32 s89, s89, 2
    v_subrev_u32 v252, s89, v249
    v_ashrrev_i32 v252, 31, v252
    s_waitcnt lgkmcnt(0)
    v_bitop3_b32 v17, v17, v252, v252 bitop3:0xf3
    v_and_b32 v252, 0x7ffffe00, v17
    v_lshrrev_b32 v253, 9, v17
    ds_write_b32 v2, v252
    v_mul_u32_u24 v253, 6, v253
    ds_read_b32 v30, v14 offset:0
    ds_read_b32 v31, v14 offset:16
    ds_read_b128 v[240:243], v4 offset:0
    ds_read_b128 v[244:247], v4 offset:16
    v_and_b32 v252, -4, v253
    buffer_load_dwordx2 v[20:21], v252, s[36:39], 0 offen
    s_waitcnt lgkmcnt(0)
    v_lshrrev_b32 v30, 2, v30
    v_lshrrev_b32 v31, 2, v31
    v_add_u32 v30, v30, v7
    v_add_u32 v31, v31, v7
    v_add_u32 v240, v240, v6
    v_add_u32 v241, v241, v6
    v_add_u32 v242, v242, v6
    v_add_u32 v243, v243, v6
    v_add_u32 v244, v244, v6
    v_add_u32 v245, v245, v6
    v_add_u32 v246, v246, v6
    v_add_u32 v247, v247, v6
    buffer_load_dwordx4 v[96:99], v30, s[32:35], 0 offen offset:0
    buffer_load_dwordx4 v[100:103], v30, s[32:35], 0 offen offset:64
    buffer_load_dwordx4 v[104:107], v31, s[32:35], 0 offen offset:0
    buffer_load_dwordx4 v[108:111], v31, s[32:35], 0 offen offset:64
    s_mov_b32 s86, 1
    s_setprio 2
    s_branch L2_head_A
L2_head_B:
    v_and_b32 v208, 127, v17
    v_lshlrev_b32 v209, 4, v208
    ds_read_b128 v[248:251], v209 offset:25600
    ds_write_b16 v3, v208 offset:256
    s_lshl_b32 s89, s63, 9
    v_add_u32 v16, s89, v8
    v_ashrrev_i32 v19, 31, v17
    s_waitcnt vmcnt(12)
    v_alignbyte_b32 v20, v21, v20, v253
    v_alignbyte_b32 v21, v21, v21, v253
    v_lshlrev_b32 v208, 16, v20
    v_and_b32 v209, v10, v20
    v_lshlrev_b32 v210, 16, v21
    s_waitcnt lgkmcnt(1)
    v_sub_f32 v208, v208, v248
    v_sub_f32 v209, v209, v249
    v_sub_f32 v210, v210, v250
    v_cvt_pk_bf16_f32 v208, 0, v208
    v_cvt_pk_bf16_f32 v209, 0, v209
    v_cvt_pk_bf16_f32 v210, 0, v210
    v_mul_f32 v211, v208, v208
    v_mul_f32 v212, v209, v209
    v_mul_f32 v213, v210, v210
    v_cvt_pk_bf16_f32 v211, 0, v211
    v_cvt_pk_bf16_f32 v212, 0, v212
    v_cvt_pk_bf16_f32 v213, 0, v213
    v_add_f32 v211, v211, v212
    v_add_f32 v211, v211, v213
    v_cvt_pk_bf16_f32 v211, 0, v211
    v_add_f32 v211, 0x322bcc77, v211
    v_cvt_pk_bf16_f32 v211, 0, v211
    v_sqrt_f32 v211, v211
    s_nop 0
    v_cvt_pk_bf16_f32 v214, 0, v211
    v_rcp_f32 v215, v214
    v_mul_f32 v220, 0x40490fdb, v214
    v_mul_f32 v216, s56, v214
    v_mul_f32 v217, s57, v214
    v_mul_f32 v218, s58, v214
    v_mul_f32 v219, s59, v214
    v_cvt_pk_bf16_f32 v220, 0, v220
    v_mul_f32 v220, 0x3e4ccccd, v220
    v_cvt_pk_bf16_f32 v216, 0, v216
    v_cvt_pk_bf16_f32 v217, 0, v217
    v_cvt_pk_bf16_f32 v220, 0, v220
    v_cvt_pk_bf16_f32 v218, 0, v218
    v_cvt_pk_bf16_f32 v219, 0, v219
    v_mul_f32 v220, 0.15915494, v220
    v_mul_f32 v208, v208, v215
    v_mul_f32 v209, v209, v215
    v_mul_f32 v210, v210, v215
    v_cos_f32 v220, v220
    v_mul_f32 v216, 0.15915494, v216
    v_mul_f32 v217, 0.15915494, v217
    v_mul_f32 v218, 0.15915494, v218
    v_mul_f32 v219, 0.15915494, v219
    v_cvt_pk_bf16_f32 v211, v208, v209
    v_cvt_pk_bf16_f32 v212, v210, v210
    v_cvt_pk_bf16_f32 v220, 0, v220
    v_sin_f32 v216, v216
    v_sin_f32 v217, v217
    v_bitop3_b32 v211, v211, v19, v19 bitop3:0x30
    v_bitop3_b32 v212, v212, v19, v19 bitop3:0x30
    v_add_f32 v220, 1.0, v220
    ds_write_b16 v3, v211 offset:384
    ds_write_b16_d16_hi v3, v211 offset:512
    ds_write_b16 v3, v212 offset:640
    ds_read_b128 v[32:35], v5 offset:256
    ds_read_b128 v[36:39], v5 offset:384
    ds_read_b128 v[40:43], v5 offset:512
    ds_read_b128 v[44:47], v5 offset:640
    v_sin_f32 v218, v218
    v_sin_f32 v219, v219
    v_cvt_pk_bf16_f32 v220, 0, v220
    v_mul_f32 v215, 0.5, v215
    v_mul_f32 v215, v215, v220
    v_mul_f32 v216, v216, v215
    v_mul_f32 v217, v217, v215
    v_mul_f32 v218, v218, v215
    v_mul_f32 v219, v219, v215
    v_cvt_pk_bf16_f32 v22, v216, v217
    v_cvt_pk_bf16_f32 v23, v218, v219
    v_bitop3_b32 v22, v22, v19, v19 bitop3:0x30
    v_bitop3_b32 v23, v23, v19, v19 bitop3:0x30
    ds_read_b128 v[224:227], v1 offset:0
    ds_read_b128 v[228:231], v1 offset:1024
    ds_read_b128 v[232:235], v1 offset:2048
    ds_read_b128 v[236:239], v1 offset:3072
    s_mov_b32 s89, 0x00010001
    s_waitcnt lgkmcnt(7)
    v_xor_b32 v32, v32, v15
    v_xor_b32 v33, v33, v15
    v_xor_b32 v34, v34, v15
    v_xor_b32 v35, v35, v15
    v_mfma_f32_16x16x4bf16_1k v[176:191], v[22:23], v[24:25], 0 cbsz:2 abid:0
    v_pk_min_u16 v32, v32, s89
    v_pk_min_u16 v33, v33, s89
    v_pk_min_u16 v34, v34, s89
    v_pk_min_u16 v35, v35, s89
    v_pk_sub_u16 v32, v32, s89
    v_pk_sub_u16 v33, v33, s89
    v_pk_sub_u16 v34, v34, s89
    v_pk_sub_u16 v35, v35, s89
    v_mfma_f32_16x16x4bf16_1k v[192:207], v[22:23], v[24:25], 0 cbsz:2 abid:1
    s_waitcnt lgkmcnt(4)
    v_and_b32 v36, v36, v32
    v_and_b32 v37, v37, v33
    v_and_b32 v38, v38, v34
    v_and_b32 v39, v39, v35
    v_and_b32 v40, v40, v32
    v_and_b32 v41, v41, v33
    v_and_b32 v42, v42, v34
    v_and_b32 v43, v43, v35
    v_and_b32 v44, v44, v32
    v_and_b32 v45, v45, v33
    v_and_b32 v46, v46, v34
    v_and_b32 v47, v47, v35
    v_and_b32 v32, 0x3f803f80, v32
    v_and_b32 v33, 0x3f803f80, v33
    v_and_b32 v34, 0x3f803f80, v34
    v_and_b32 v35, 0x3f803f80, v35
    buffer_load_dwordx2 v[48:49], v240, s[28:31], 0 offen offset:128
    buffer_load_dwordx2 v[50:51], v241, s[28:31], 0 offen offset:128
    buffer_load_dwordx2 v[52:53], v242, s[28:31], 0 offen offset:128
    buffer_load_dwordx2 v[54:55], v243, s[28:31], 0 offen offset:128
    buffer_load_dwordx2 v[56:57], v244, s[28:31], 0 offen offset:128
    buffer_load_dwordx2 v[58:59], v245, s[28:31], 0 offen offset:128
    buffer_load_dwordx2 v[60:61], v246, s[28:31], 0 offen offset:128
    buffer_load_dwordx2 v[62:63], v247, s[28:31], 0 offen offset:128
    s_waitcnt vmcnt(16)
    s_waitcnt lgkmcnt(2)
    v_mfma_f32_16x16x32_bf16 v[208:211], v[96:99], v[224:227], 0
    v_mfma_f32_16x16x32_bf16 v[212:215], v[104:107], v[224:227], 0
    v_mfma_f32_16x16x32_bf16 v[208:211], v[100:103], v[228:231], v[208:211]
    v_mfma_f32_16x16x32_bf16 v[212:215], v[108:111], v[228:231], v[212:215]
    ds_read_b128 v[224:227], v1 offset:4096
    ds_read_b128 v[228:231], v1 offset:5120
    s_waitcnt lgkmcnt(2)
    v_mfma_f32_16x16x32_bf16 v[216:219], v[96:99], v[232:235], 0
    s_nop 2
    v_mul_f32 v208, v208, v176
    v_mul_f32 v209, v209, v177
    v_mfma_f32_16x16x32_bf16 v[220:223], v[104:107], v[232:235], 0
    v_mul_f32 v210, v210, v178
    v_mul_f32 v211, v211, v179
    v_mfma_f32_16x16x32_bf16 v[216:219], v[100:103], v[236:239], v[216:219]
    v_mul_f32 v212, v212, v192
    v_mul_f32 v213, v213, v193
    v_mfma_f32_16x16x32_bf16 v[220:223], v[108:111], v[236:239], v[220:223]
    v_mul_f32 v214, v214, v194
    v_mul_f32 v215, v215, v195
    v_cvt_pk_bf16_f32 v208, v208, v209
    v_cvt_pk_bf16_f32 v209, v210, v211
    v_cvt_pk_bf16_f32 v210, v212, v213
    v_cvt_pk_bf16_f32 v211, v214, v215
    ds_read_b128 v[232:235], v1 offset:6144
    ds_read_b128 v[236:239], v1 offset:7168
    v_mfma_f32_16x16x32_bf16 v[112:115], v[208:211], v[32:35], v[112:115]
    s_waitcnt lgkmcnt(2)
    v_mfma_f32_16x16x32_bf16 v[208:211], v[96:99], v[224:227], 0
    v_mul_f32 v216, v216, v180
    v_mul_f32 v217, v217, v181
    v_mfma_f32_16x16x32_bf16 v[212:215], v[104:107], v[224:227], 0
    v_mul_f32 v218, v218, v182
    v_mul_f32 v219, v219, v183
    v_mfma_f32_16x16x32_bf16 v[208:211], v[100:103], v[228:231], v[208:211]
    v_mul_f32 v220, v220, v196
    v_mul_f32 v221, v221, v197
    v_mfma_f32_16x16x32_bf16 v[212:215], v[108:111], v[228:231], v[212:215]
    v_mul_f32 v222, v222, v198
    v_mul_f32 v223, v223, v199
    v_cvt_pk_bf16_f32 v216, v216, v217
    v_cvt_pk_bf16_f32 v217, v218, v219
    v_cvt_pk_bf16_f32 v218, v220, v221
    v_cvt_pk_bf16_f32 v219, v222, v223
    ds_read_b128 v[224:227], v1 offset:16384
    ds_read_b128 v[228:231], v1 offset:17408
    v_mfma_f32_16x16x32_bf16 v[116:119], v[216:219], v[32:35], v[116:119]
    s_waitcnt lgkmcnt(2)
    v_mfma_f32_16x16x32_bf16 v[216:219], v[96:99], v[232:235], 0
    v_mul_f32 v208, v208, v184
    v_mul_f32 v209, v209, v185
    v_mfma_f32_16x16x32_bf16 v[220:223], v[104:107], v[232:235], 0
    v_mul_f32 v210, v210, v186
    v_mul_f32 v211, v211, v187
    v_mfma_f32_16x16x32_bf16 v[216:219], v[100:103], v[236:239], v[216:219]
    v_mul_f32 v212, v212, v200
    v_mul_f32 v213, v213, v201
    v_mfma_f32_16x16x32_bf16 v[220:223], v[108:111], v[236:239], v[220:223]
    v_mul_f32 v214, v214, v202
    v_mul_f32 v215, v215, v203
    v_cvt_pk_bf16_f32 v208, v208, v209
    v_cvt_pk_bf16_f32 v209, v210, v211
    v_cvt_pk_bf16_f32 v210, v212, v213
    v_cvt_pk_bf16_f32 v211, v214, v215
    ds_read_b128 v[232:235], v1 offset:18432
    ds_read_b128 v[236:239], v1 offset:19456
    v_mfma_f32_16x16x32_bf16 v[120:123], v[208:211], v[32:35], v[120:123]
    buffer_load_dwordx2 v[64:65], v240, s[28:31], 0 offen offset:256
    buffer_load_dwordx2 v[66:67], v241, s[28:31], 0 offen offset:256
    buffer_load_dwordx2 v[68:69], v242, s[28:31], 0 offen offset:256
    buffer_load_dwordx2 v[70:71], v243, s[28:31], 0 offen offset:256
    buffer_load_dwordx2 v[72:73], v244, s[28:31], 0 offen offset:256
    buffer_load_dwordx2 v[74:75], v245, s[28:31], 0 offen offset:256
    buffer_load_dwordx2 v[76:77], v246, s[28:31], 0 offen offset:256
    buffer_load_dwordx2 v[78:79], v247, s[28:31], 0 offen offset:256
    s_waitcnt lgkmcnt(2)
    v_mfma_f32_16x16x32_bf16 v[208:211], v[96:99], v[224:227], 0
    v_mul_f32 v216, v216, v188
    v_mul_f32 v217, v217, v189
    v_mfma_f32_16x16x32_bf16 v[212:215], v[104:107], v[224:227], 0
    v_mul_f32 v218, v218, v190
    v_mul_f32 v219, v219, v191
    v_mfma_f32_16x16x32_bf16 v[208:211], v[100:103], v[228:231], v[208:211]
    v_mul_f32 v220, v220, v204
    v_mul_f32 v221, v221, v205
    v_mfma_f32_16x16x32_bf16 v[212:215], v[108:111], v[228:231], v[212:215]
    v_mul_f32 v222, v222, v206
    v_mul_f32 v223, v223, v207
    v_mfma_f32_16x16x4bf16_1k v[176:191], v[22:23], v[28:29], 0 cbsz:2 abid:0
    v_mfma_f32_16x16x4bf16_1k v[192:207], v[22:23], v[28:29], 0 cbsz:2 abid:1
    v_cvt_pk_bf16_f32 v216, v216, v217
    v_cvt_pk_bf16_f32 v217, v218, v219
    v_cvt_pk_bf16_f32 v218, v220, v221
    v_cvt_pk_bf16_f32 v219, v222, v223
    ds_read_b128 v[224:227], v1 offset:20480
    ds_read_b128 v[228:231], v1 offset:21504
    v_mfma_f32_16x16x32_bf16 v[124:127], v[216:219], v[32:35], v[124:127]
    s_waitcnt lgkmcnt(2)
    v_mfma_f32_16x16x32_bf16 v[216:219], v[96:99], v[232:235], 0
    v_mfma_f32_16x16x32_bf16 v[220:223], v[104:107], v[232:235], 0
    s_nop 0
    v_mul_f32 v208, v208, v176
    v_mul_f32 v209, v209, v177
    v_mul_f32 v210, v210, v178
    v_mul_f32 v211, v211, v179
    v_mfma_f32_16x16x32_bf16 v[216:219], v[100:103], v[236:239], v[216:219]
    v_mul_f32 v212, v212, v192
    v_mul_f32 v213, v213, v193
    v_mfma_f32_16x16x32_bf16 v[220:223], v[108:111], v[236:239], v[220:223]
    v_mul_f32 v214, v214, v194
    v_mul_f32 v215, v215, v195
    v_cvt_pk_bf16_f32 v208, v208, v209
    v_cvt_pk_bf16_f32 v209, v210, v211
    v_cvt_pk_bf16_f32 v210, v212, v213
    v_cvt_pk_bf16_f32 v211, v214, v215
    ds_read_b128 v[232:235], v1 offset:22528
    ds_read_b128 v[236:239], v1 offset:23552
    v_mfma_f32_16x16x32_bf16 v[128:131], v[208:211], v[36:39], v[128:131]
    v_mfma_f32_16x16x32_bf16 v[144:147], v[208:211], v[40:43], v[144:147]
    v_mfma_f32_16x16x32_bf16 v[160:163], v[208:211], v[44:47], v[160:163]
    s_waitcnt lgkmcnt(2)
    v_mfma_f32_16x16x32_bf16 v[208:211], v[96:99], v[224:227], 0
    v_mul_f32 v216, v216, v180
    v_mul_f32 v217, v217, v181
    v_mfma_f32_16x16x32_bf16 v[212:215], v[104:107], v[224:227], 0
    v_mul_f32 v218, v218, v182
    v_mul_f32 v219, v219, v183
    v_mfma_f32_16x16x32_bf16 v[208:211], v[100:103], v[228:231], v[208:211]
    v_mul_f32 v220, v220, v196
    v_mul_f32 v221, v221, v197
    v_mfma_f32_16x16x32_bf16 v[212:215], v[108:111], v[228:231], v[212:215]
    v_mul_f32 v222, v222, v198
    v_mul_f32 v223, v223, v199
    v_cvt_pk_bf16_f32 v216, v216, v217
    v_cvt_pk_bf16_f32 v217, v218, v219
    v_cvt_pk_bf16_f32 v218, v220, v221
    v_cvt_pk_bf16_f32 v219, v222, v223
    ds_read_b128 v[224:227], v1 offset:8192
    ds_read_b128 v[228:231], v1 offset:9216
    v_mfma_f32_16x16x32_bf16 v[132:135], v[216:219], v[36:39], v[132:135]
    v_mfma_f32_16x16x32_bf16 v[148:151], v[216:219], v[40:43], v[148:151]
    v_mfma_f32_16x16x32_bf16 v[164:167], v[216:219], v[44:47], v[164:167]
    s_waitcnt lgkmcnt(2)
    v_mfma_f32_16x16x32_bf16 v[216:219], v[96:99], v[232:235], 0
    v_mul_f32 v208, v208, v184
    v_mul_f32 v209, v209, v185
    v_mfma_f32_16x16x32_bf16 v[220:223], v[104:107], v[232:235], 0
    v_mul_f32 v210, v210, v186
    v_mul_f32 v211, v211, v187
    v_mfma_f32_16x16x32_bf16 v[216:219], v[100:103], v[236:239], v[216:219]
    v_mul_f32 v212, v212, v200
    v_mul_f32 v213, v213, v201
    v_mfma_f32_16x16x32_bf16 v[220:223], v[108:111], v[236:239], v[220:223]
    v_mul_f32 v214, v214, v202
    v_mul_f32 v215, v215, v203
    v_cvt_pk_bf16_f32 v208, v208, v209
    v_cvt_pk_bf16_f32 v209, v210, v211
    v_cvt_pk_bf16_f32 v210, v212, v213
    v_cvt_pk_bf16_f32 v211, v214, v215
    ds_read_b128 v[232:235], v1 offset:10240
    ds_read_b128 v[236:239], v1 offset:11264
    v_mfma_f32_16x16x32_bf16 v[136:139], v[208:211], v[36:39], v[136:139]
    v_mfma_f32_16x16x32_bf16 v[152:155], v[208:211], v[40:43], v[152:155]
    v_mfma_f32_16x16x32_bf16 v[168:171], v[208:211], v[44:47], v[168:171]
    buffer_load_dwordx2 v[80:81], v240, s[28:31], 0 offen offset:384
    buffer_load_dwordx2 v[82:83], v241, s[28:31], 0 offen offset:384
    buffer_load_dwordx2 v[84:85], v242, s[28:31], 0 offen offset:384
    buffer_load_dwordx2 v[86:87], v243, s[28:31], 0 offen offset:384
    buffer_load_dwordx2 v[88:89], v244, s[28:31], 0 offen offset:384
    buffer_load_dwordx2 v[90:91], v245, s[28:31], 0 offen offset:384
    buffer_load_dwordx2 v[92:93], v246, s[28:31], 0 offen offset:384
    buffer_load_dwordx2 v[94:95], v247, s[28:31], 0 offen offset:384
    s_waitcnt lgkmcnt(2)
    v_mfma_f32_16x16x32_bf16 v[208:211], v[96:99], v[224:227], 0
    v_mul_f32 v216, v216, v188
    v_mul_f32 v217, v217, v189
    v_mfma_f32_16x16x32_bf16 v[212:215], v[104:107], v[224:227], 0
    v_mul_f32 v218, v218, v190
    v_mul_f32 v219, v219, v191
    v_mfma_f32_16x16x32_bf16 v[208:211], v[100:103], v[228:231], v[208:211]
    v_mul_f32 v220, v220, v204
    v_mul_f32 v221, v221, v205
    v_mfma_f32_16x16x32_bf16 v[212:215], v[108:111], v[228:231], v[212:215]
    v_mul_f32 v222, v222, v206
    v_mul_f32 v223, v223, v207
    v_mfma_f32_16x16x4bf16_1k v[176:191], v[22:23], v[26:27], 0 cbsz:2 abid:0
    v_mfma_f32_16x16x4bf16_1k v[192:207], v[22:23], v[26:27], 0 cbsz:2 abid:1
    v_cvt_pk_bf16_f32 v216, v216, v217
    v_cvt_pk_bf16_f32 v217, v218, v219
    v_cvt_pk_bf16_f32 v218, v220, v221
    v_cvt_pk_bf16_f32 v219, v222, v223
    ds_read_b128 v[224:227], v1 offset:12288
    ds_read_b128 v[228:231], v1 offset:13312
    v_mfma_f32_16x16x32_bf16 v[140:143], v[216:219], v[36:39], v[140:143]
    v_mfma_f32_16x16x32_bf16 v[156:159], v[216:219], v[40:43], v[156:159]
    v_mfma_f32_16x16x32_bf16 v[172:175], v[216:219], v[44:47], v[172:175]
    s_waitcnt lgkmcnt(2)
    v_mfma_f32_16x16x32_bf16 v[216:219], v[96:99], v[232:235], 0
    v_mfma_f32_16x16x32_bf16 v[220:223], v[104:107], v[232:235], 0
    v_mul_f32 v176, v208, v176
    v_mul_f32 v177, v209, v177
    v_mul_f32 v178, v210, v178
    v_mul_f32 v179, v211, v179
    v_mfma_f32_16x16x32_bf16 v[216:219], v[100:103], v[236:239], v[216:219]
    v_mul_f32 v192, v212, v192
    v_mul_f32 v193, v213, v193
    v_mfma_f32_16x16x32_bf16 v[220:223], v[108:111], v[236:239], v[220:223]
    v_mul_f32 v194, v214, v194
    v_mul_f32 v195, v215, v195
    ds_read_b128 v[232:235], v1 offset:14336
    ds_read_b128 v[236:239], v1 offset:15360
    s_waitcnt lgkmcnt(2)
    v_mfma_f32_16x16x32_bf16 v[208:211], v[96:99], v[224:227], 0
    v_mul_f32 v180, v216, v180
    v_mul_f32 v181, v217, v181
    v_mfma_f32_16x16x32_bf16 v[212:215], v[104:107], v[224:227], 0
    v_mul_f32 v182, v218, v182
    v_mul_f32 v183, v219, v183
    v_mfma_f32_16x16x32_bf16 v[208:211], v[100:103], v[228:231], v[208:211]
    v_mul_f32 v196, v220, v196
    v_mul_f32 v197, v221, v197
    v_mfma_f32_16x16x32_bf16 v[212:215], v[108:111], v[228:231], v[212:215]
    v_mul_f32 v198, v222, v198
    v_mul_f32 v199, v223, v199
    s_waitcnt lgkmcnt(0)
    v_mfma_f32_16x16x32_bf16 v[216:219], v[96:99], v[232:235], 0
    s_nop 0
    v_mul_f32 v184, v208, v184
    v_mul_f32 v185, v209, v185
    v_mfma_f32_16x16x32_bf16 v[220:223], v[104:107], v[232:235], 0
    v_mul_f32 v186, v210, v186
    v_mul_f32 v187, v211, v187
    v_mfma_f32_16x16x32_bf16 v[216:219], v[100:103], v[236:239], v[216:219]
    v_mul_f32 v200, v212, v200
    v_mul_f32 v201, v213, v201
    v_mfma_f32_16x16x32_bf16 v[220:223], v[108:111], v[236:239], v[220:223]
    v_mul_f32 v202, v214, v202
    v_mul_f32 v203, v215, v203
    s_add_u32 s70, s84, 32
    s_cmp_lt_u32 s70, s85
    s_nop 3
    s_cbranch_scc1 L2_tail_toC
    s_branch L2_newitem
L2_head_A:
    v_and_b32 v208, 127, v17
    v_lshlrev_b32 v209, 4, v208
    ds_read_b128 v[248:251], v209 offset:25600
    ds_write_b16 v3, v208 offset:256
    s_lshl_b32 s89, s63, 9
    v_add_u32 v16, s89, v8
    s_mul_i32 s89, s63, 0x10001
    v_add_u32 v15, s89, v9
    s_bfm_b32 s90, s26, 0
    s_lshl_b32 s91, s90, 16
    s_or_b32 s22, s90, s91
    s_mov_b32 s23, s22
    v_and_b32 v211, 0xff, v15
    v_and_b32 v212, 7, v15
    v_lshlrev_b32 v212, 5, v212
    v_xor_b32 v212, v212, v7
    v_lshl_add_u32 v211, v211, 9, v212
    v_add_u32 v211, 50176, v211
    ds_read_b128 v[176:179], v211
    v_xor_b32 v213, 64, v211
    ds_read_b128 v[180:183], v213
    v_xor_b32 v212, 128, v211
    ds_read_b128 v[184:187], v212
    v_xor_b32 v213, 192, v211
    ds_read_b128 v[188:191], v213
    v_xor_b32 v212, 256, v211
    ds_read_b128 v[192:195], v212
    v_xor_b32 v213, 320, v211
    ds_read_b128 v[196:199], v213
    v_xor_b32 v212, 384, v211
    ds_read_b128 v[200:203], v212
    v_xor_b32 v213, 448, v211
    ds_read_b128 v[204:207], v213
    v_ashrrev_i32 v19, 31, v17
    s_cmp_eq_u32 s86, 0
    s_cbranch_scc1 L2_notfirst1
    s_waitcnt vmcnt(4)
L2_notfirst1:
    s_waitcnt vmcnt(12)
    v_alignbyte_b32 v20, v21, v20, v253
    v_alignbyte_b32 v21, v21, v21, v253
    v_lshlrev_b32 v208, 16, v20
    v_and_b32 v209, v10, v20
    v_lshlrev_b32 v210, 16, v21
    s_waitcnt lgkmcnt(9)
    v_sub_f32 v208, v208, v248
    v_sub_f32 v209, v209, v249
    v_sub_f32 v210, v210, v250
    v_cvt_pk_bf16_f32 v208, 0, v208
    v_cvt_pk_bf16_f32 v209, 0, v209
    v_cvt_pk_bf16_f32 v210, 0, v210
    v_mul_f32 v211, v208, v208
    v_mul_f32 v212, v209, v209
    v_mul_f32 v213, v210, v210
    s_waitcnt lgkmcnt(0)
    v_cvt_pk_bf16_f32 v211, 0, v211
    v_lshlrev_b32 v112, 16, v176
    v_cvt_pk_bf16_f32 v212, 0, v212
    v_lshlrev_b32 v113, 16, v178
    v_cvt_pk_bf16_f32 v213, 0, v213
    v_and_b32 v116, v10, v176
    v_add_f32 v211, v211, v212
    v_and_b32 v117, v10, v178
    v_add_f32 v211, v211, v213
    v_lshlrev_b32 v120, 16, v177
    v_cvt_pk_bf16_f32 v211, 0, v211
    v_lshlrev_b32 v121, 16, v179
    v_add_f32 v211, 0x322bcc77, v211
    v_and_b32 v124, v10, v177
    v_cvt_pk_bf16_f32 v211, 0, v211
    v_and_b32 v125, v10, v179
    v_sqrt_f32 v211, v211
    v_lshlrev_b32 v114, 16, v180
    v_cvt_pk_bf16_f32 v214, 0, v211
    v_lshlrev_b32 v115, 16, v182
    v_rcp_f32 v215, v214
    v_and_b32 v118, v10, v180
    v_mul_f32 v220, 0x40490fdb, v214
    v_and_b32 v119, v10, v182
    v_mul_f32 v216, s56, v214
    v_lshlrev_b32 v122, 16, v181
    v_mul_f32 v217, s57, v214
    v_lshlrev_b32 v123, 16, v183
    v_mul_f32 v218, s58, v214
    v_and_b32 v126, v10, v181
    v_and_b32 v127, v10, v183
    v_mul_f32 v219, s59, v214
    v_lshlrev_b32 v128, 16, v184
    v_cvt_pk_bf16_f32 v220, 0, v220
    v_lshlrev_b32 v129, 16, v186
    v_mul_f32 v220, 0x3e4ccccd, v220
    v_and_b32 v132, v10, v184
    v_cvt_pk_bf16_f32 v216, 0, v216
    v_and_b32 v133, v10, v186
    v_cvt_pk_bf16_f32 v217, 0, v217
    v_lshlrev_b32 v136, 16, v185
    v_cvt_pk_bf16_f32 v220, 0, v220
    v_lshlrev_b32 v137, 16, v187
    v_cvt_pk_bf16_f32 v218, 0, v218
    v_and_b32 v140, v10, v185
    v_cvt_pk_bf16_f32 v219, 0, v219
    v_and_b32 v141, v10, v187
    v_mul_f32 v220, 0.15915494, v220
    v_lshlrev_b32 v130, 16, v188
    v_mul_f32 v208, v208, v215
    v_lshlrev_b32 v131, 16, v190
    v_mul_f32 v209, v209, v215
    v_and_b32 v134, v10, v188
    v_mul_f32 v210, v210, v215
    v_and_b32 v135, v10, v190
    v_cos_f32 v220, v220
    v_lshlrev_b32 v138, 16, v189
    v_mul_f32 v216, 0.15915494, v216
    v_lshlrev_b32 v139, 16, v191
    v_mul_f32 v217, 0.15915494, v217
    v_and_b32 v142, v10, v189
    v_and_b32 v143, v10, v191
    v_mul_f32 v218, 0.15915494, v218
    v_lshlrev_b32 v144, 16, v192
    v_mul_f32 v219, 0.15915494, v219
    v_lshlrev_b32 v145, 16, v194
    v_cvt_pk_bf16_f32 v211, v208, v209
    v_and_b32 v148, v10, v192
    v_cvt_pk_bf16_f32 v212, v210, v210
    v_and_b32 v149, v10, v194
    v_cvt_pk_bf16_f32 v220, 0, v220
    v_lshlrev_b32 v152, 16, v193
    v_sin_f32 v216, v216
    v_lshlrev_b32 v153, 16, v195
    v_sin_f32 v217, v217
    v_and_b32 v156, v10, v193
    v_bitop3_b32 v211, v211, v19, v19 bitop3:0x30
    v_and_b32 v157, v10, v195
    v_bitop3_b32 v212, v212, v19, v19 bitop3:0x30
    v_lshlrev_b32 v146, 16, v196
    v_add_f32 v220, 1.0, v220
    v_lshlrev_b32 v147, 16, v198
    ds_write_b16 v3, v211 offset:384
    v_and_b32 v150, v10, v196
    ds_write_b16_d16_hi v3, v211 offset:512
    v_and_b32 v151, v10, v198
    ds_write_b16 v3, v212 offset:640
    v_lshlrev_b32 v154, 16, v197
    ds_read_b128 v[32:35], v5 offset:256
    v_lshlrev_b32 v155, 16, v199
    ds_read_b128 v[36:39], v5 offset:384
    v_and_b32 v158, v10, v197
    v_and_b32 v159, v10, v199
    ds_read_b128 v[40:43], v5 offset:512
    v_lshlrev_b32 v160, 16, v200
    ds_read_b128 v[44:47], v5 offset:640
    v_lshlrev_b32 v161, 16, v202
    v_sin_f32 v218, v218
    v_and_b32 v164, v10, v200
    v_sin_f32 v219, v219
    v_and_b32 v165, v10, v202
    v_cvt_pk_bf16_f32 v220, 0, v220
    v_lshlrev_b32 v168, 16, v201
    v_mul_f32 v215, 0.5, v215
    v_lshlrev_b32 v169, 16, v203
    v_mul_f32 v215, v215, v220
    v_and_b32 v172, v10, v201
    v_mul_f32 v216, v216, v215
    v_and_b32 v173, v10, v203
    v_mul_f32 v217, v217, v215
    v_lshlrev_b32 v162, 16, v204
    v_mul_f32 v218, v218, v215
    v_lshlrev_b32 v163, 16, v206
    v_mul_f32 v219, v219, v215
    v_and_b32 v166, v10, v204
    v_cvt_pk_bf16_f32 v22, v216, v217
    v_and_b32 v167, v10, v206
    v_cvt_pk_bf16_f32 v23, v218, v219
    v_lshlrev_b32 v170, 16, v205
    v_bitop3_b32 v22, v22, v19, v19 bitop3:0x30
    v_lshlrev_b32 v171, 16, v207
    v_bitop3_b32 v23, v23, v19, v19 bitop3:0x30
    v_and_b32 v174, v10, v205
    v_and_b32 v175, v10, v207
    ds_read_b128 v[224:227], v1 offset:0
    ds_read_b128 v[228:231], v1 offset:1024
    ds_read_b128 v[232:235], v1 offset:2048
    ds_read_b128 v[236:239], v1 offset:3072
    s_mov_b32 s89, 0x00010001
    s_waitcnt lgkmcnt(7)
    v_xor_b32 v32, v32, v15
    v_xor_b32 v33, v33, v15
    v_xor_b32 v34, v34, v15
    v_xor_b32 v35, v35, v15
    v_mfma_f32_16x16x4bf16_1k v[176:191], v[22:23], v[24:25], 0 cbsz:2 abid:0
    v_pk_min_u16 v32, v32, s89
    v_pk_min_u16 v33, v33, s89
    v_pk_min_u16 v34, v34, s89
    v_pk_min_u16 v35, v35, s89
    v_pk_sub_u16 v32, v32, s89
    v_pk_sub_u16 v33, v33, s89
    v_pk_sub_u16 v34, v34, s89
    v_pk_sub_u16 v35, v35, s89
    v_mfma_f32_16x16x4bf16_1k v[192:207], v[22:23], v[24:25], 0 cbsz:2 abid:1
    s_waitcnt lgkmcnt(4)
    v_and_b32 v36, v36, v32
    v_and_b32 v37, v37, v33
    v_and_b32 v38, v38, v34
    v_and_b32 v39, v39, v35
    v_and_b32 v40, v40, v32
    v_and_b32 v41, v41, v33
    v_and_b32 v42, v42, v34
    v_and_b32 v43, v43, v35
    v_and_b32 v44, v44, v32
    v_and_b32 v45, v45, v33
    v_and_b32 v46, v46, v34
    v_and_b32 v47, v47, v35
    v_and_b32 v32, 0x3f803f80, v32
    v_and_b32 v33, 0x3f803f80, v33
    v_and_b32 v34, 0x3f803f80, v34
    v_and_b32 v35, 0x3f803f80, v35
    buffer_load_dwordx2 v[48:49], v240, s[28:31], 0 offen offset:128
    buffer_load_dwordx2 v[50:51], v241, s[28:31], 0 offen offset:128
    buffer_load_dwordx2 v[52:53], v242, s[28:31], 0 offen offset:128
    buffer_load_dwordx2 v[54:55], v243, s[28:31], 0 offen offset:128
    buffer_load_dwordx2 v[56:57], v244, s[28:31], 0 offen offset:128
    buffer_load_dwordx2 v[58:59], v245, s[28:31], 0 offen offset:128
    buffer_load_dwordx2 v[60:61], v246, s[28:31], 0 offen offset:128
    buffer_load_dwordx2 v[62:63], v247, s[28:31], 0 offen offset:128
    s_cmp_eq_u32 s86, 0
    s_cbranch_scc1 L2_notfirst2
    s_waitcnt vmcnt(8)
    s_mov_b32 s86, 0
L2_notfirst2:
    s_waitcnt vmcnt(16)
    s_waitcnt lgkmcnt(2)
    v_mfma_f32_16x16x32_bf16 v[208:211], v[96:99], v[224:227], 0
    v_mfma_f32_16x16x32_bf16 v[212:215], v[104:107], v[224:227], 0
    v_mfma_f32_16x16x32_bf16 v[208:211], v[100:103], v[228:231], v[208:211]
    v_mfma_f32_16x16x32_bf16 v[212:215], v[108:111], v[228:231], v[212:215]
    ds_read_b128 v[224:227], v1 offset:4096
    ds_read_b128 v[228:231], v1 offset:5120
    s_waitcnt lgkmcnt(2)
    v_mfma_f32_16x16x32_bf16 v[216:219], v[96:99], v[232:235], 0
    s_nop 2
    v_mul_f32 v208, v208, v176
    v_mul_f32 v209, v209, v177
    v_mfma_f32_16x16x32_bf16 v[220:223], v[104:107], v[232:235], 0
    v_mul_f32 v210, v210, v178
    v_mul_f32 v211, v211, v179
    v_mfma_f32_16x16x32_bf16 v[216:219], v[100:103], v[236:239], v[216:219]
    v_mul_f32 v212, v212, v192
    v_mul_f32 v213, v213, v193
    v_mfma_f32_16x16x32_bf16 v[220:223], v[108:111], v[236:239], v[220:223]
    v_mul_f32 v214, v214, v194
    v_mul_f32 v215, v215, v195
    v_cvt_pk_bf16_f32 v208, v208, v209
    v_cvt_pk_bf16_f32 v209, v210, v211
    v_cvt_pk_bf16_f32 v210, v212, v213
    v_cvt_pk_bf16_f32 v211, v214, v215
    ds_read_b128 v[232:235], v1 offset:6144
    ds_read_b128 v[236:239], v1 offset:7168
    v_mfma_f32_16x16x32_bf16 v[112:115], v[208:211], v[32:35], v[112:115]
    s_waitcnt lgkmcnt(2)
    v_mfma_f32_16x16x32_bf16 v[208:211], v[96:99], v[224:227], 0
    v_mul_f32 v216, v216, v180
    v_mul_f32 v217, v217, v181
    v_mfma_f32_16x16x32_bf16 v[212:215], v[104:107], v[224:227], 0
    v_mul_f32 v218, v218, v182
    v_mul_f32 v219, v219, v183
    v_mfma_f32_16x16x32_bf16 v[208:211], v[100:103], v[228:231], v[208:211]
    v_mul_f32 v220, v220, v196
    v_mul_f32 v221, v221, v197
    v_mfma_f32_16x16x32_bf16 v[212:215], v[108:111], v[228:231], v[212:215]
    v_mul_f32 v222, v222, v198
    v_mul_f32 v223, v223, v199
    v_cvt_pk_bf16_f32 v216, v216, v217
    v_cvt_pk_bf16_f32 v217, v218, v219
    v_cvt_pk_bf16_f32 v218, v220, v221
    v_cvt_pk_bf16_f32 v219, v222, v223
    ds_read_b128 v[224:227], v1 offset:16384
    ds_read_b128 v[228:231], v1 offset:17408
    v_mfma_f32_16x16x32_bf16 v[116:119], v[216:219], v[32:35], v[116:119]
    s_waitcnt lgkmcnt(2)
    v_mfma_f32_16x16x32_bf16 v[216:219], v[96:99], v[232:235], 0
    v_mul_f32 v208, v208, v184
    v_mul_f32 v209, v209, v185
    v_mfma_f32_16x16x32_bf16 v[220:223], v[104:107], v[232:235], 0
    v_mul_f32 v210, v210, v186
    v_mul_f32 v211, v211, v187
    v_mfma_f32_16x16x32_bf16 v[216:219], v[100:103], v[236:239], v[216:219]
    v_mul_f32 v212, v212, v200
    v_mul_f32 v213, v213, v201
    v_mfma_f32_16x16x32_bf16 v[220:223], v[108:111], v[236:239], v[220:223]
    v_mul_f32 v214, v214, v202
    v_mul_f32 v215, v215, v203
    v_cvt_pk_bf16_f32 v208, v208, v209
    v_cvt_pk_bf16_f32 v209, v210, v211
    v_cvt_pk_bf16_f32 v210, v212, v213
    v_cvt_pk_bf16_f32 v211, v214, v215
    ds_read_b128 v[232:235], v1 offset:18432
    ds_read_b128 v[236:239], v1 offset:19456
    v_mfma_f32_16x16x32_bf16 v[120:123], v[208:211], v[32:35], v[120:123]
    buffer_load_dwordx2 v[64:65], v240, s[28:31], 0 offen offset:256
    buffer_load_dwordx2 v[66:67], v241, s[28:31], 0 offen offset:256
    buffer_load_dwordx2 v[68:69], v242, s[28:31], 0 offen offset:256
    buffer_load_dwordx2 v[70:71], v243, s[28:31], 0 offen offset:256
    buffer_load_dwordx2 v[72:73], v244, s[28:31], 0 offen offset:256
    buffer_load_dwordx2 v[74:75], v245, s[28:31], 0 offen offset:256
    buffer_load_dwordx2 v[76:77], v246, s[28:31], 0 offen offset:256
    buffer_load_dwordx2 v[78:79], v247, s[28:31], 0 offen offset:256
    s_waitcnt lgkmcnt(2)
    v_mfma_f32_16x16x32_bf16 v[208:211], v[96:99], v[224:227], 0
    v_mul_f32 v216, v216, v188
    v_mul_f32 v217, v217, v189
    v_mfma_f32_16x16x32_bf16 v[212:215], v[104:107], v[224:227], 0
    v_mul_f32 v218, v218, v190
    v_mul_f32 v219, v219, v191
    v_mfma_f32_16x16x32_bf16 v[208:211], v[100:103], v[228:231], v[208:211]
    v_mul_f32 v220, v220, v204
    v_mul_f32 v221, v221, v205
    v_mfma_f32_16x16x32_bf16 v[212:215], v[108:111], v[228:231], v[212:215]
    v_mul_f32 v222, v222, v206
    v_mul_f32 v223, v223, v207
    v_mfma_f32_16x16x4bf16_1k v[176:191], v[22:23], v[28:29], 0 cbsz:2 abid:0
    v_mfma_f32_16x16x4bf16_1k v[192:207], v[22:23], v[28:29], 0 cbsz:2 abid:1
    v_cvt_pk_bf16_f32 v216, v216, v217
    v_cvt_pk_bf16_f32 v217, v218, v219
    v_cvt_pk_bf16_f32 v218, v220, v221
    v_cvt_pk_bf16_f32 v219, v222, v223
    ds_read_b128 v[224:227], v1 offset:20480
    ds_read_b128 v[228:231], v1 offset:21504
    v_mfma_f32_16x16x32_bf16 v[124:127], v[216:219], v[32:35], v[124:127]
    s_waitcnt lgkmcnt(2)
    v_mfma_f32_16x16x32_bf16 v[216:219], v[96:99], v[232:235], 0
    v_mfma_f32_16x16x32_bf16 v[220:223], v[104:107], v[232:235], 0
    s_nop 0
    v_mul_f32 v208, v208, v176
    v_mul_f32 v209, v209, v177
    v_mul_f32 v210, v210, v178
    v_mul_f32 v211, v211, v179
    v_mfma_f32_16x16x32_bf16 v[216:219], v[100:103], v[236:239], v[216:219]
    v_mul_f32 v212, v212, v192
    v_mul_f32 v213, v213, v193
    v_mfma_f32_16x16x32_bf16 v[220:223], v[108:111], v[236:239], v[220:223]
    v_mul_f32 v214, v214, v194
    v_mul_f32 v215, v215, v195
    v_cvt_pk_bf16_f32 v208, v208, v209
    v_cvt_pk_bf16_f32 v209, v210, v211
    v_cvt_pk_bf16_f32 v210, v212, v213
    v_cvt_pk_bf16_f32 v211, v214, v215
    ds_read_b128 v[232:235], v1 offset:22528
    ds_read_b128 v[236:239], v1 offset:23552
    v_mfma_f32_16x16x32_bf16 v[128:131], v[208:211], v[36:39], v[128:131]
    v_mfma_f32_16x16x32_bf16 v[144:147], v[208:211], v[40:43], v[144:147]
    v_mfma_f32_16x16x32_bf16 v[160:163], v[208:211], v[44:47], v[160:163]
    s_waitcnt lgkmcnt(2)
    v_mfma_f32_16x16x32_bf16 v[208:211], v[96:99], v[224:227], 0
    v_mul_f32 v216, v216, v180
    v_mul_f32 v217, v217, v181
    v_mfma_f32_16x16x32_bf16 v[212:215], v[104:107], v[224:227], 0
    v_mul_f32 v218, v218, v182
    v_mul_f32 v219, v219, v183
    v_mfma_f32_16x16x32_bf16 v[208:211], v[100:103], v[228:231], v[208:211]
    v_mul_f32 v220, v220, v196
    v_mul_f32 v221, v221, v197
    v_mfma_f32_16x16x32_bf16 v[212:215], v[108:111], v[228:231], v[212:215]
    v_mul_f32 v222, v222, v198
    v_mul_f32 v223, v223, v199
    v_cvt_pk_bf16_f32 v216, v216, v217
    v_cvt_pk_bf16_f32 v217, v218, v219
    v_cvt_pk_bf16_f32 v218, v220, v221
    v_cvt_pk_bf16_f32 v219, v222, v223
    ds_read_b128 v[224:227], v1 offset:8192
    ds_read_b128 v[228:231], v1 offset:9216
    v_mfma_f32_16x16x32_bf16 v[132:135], v[216:219], v[36:39], v[132:135]
    v_mfma_f32_16x16x32_bf16 v[148:151], v[216:219], v[40:43], v[148:151]
    v_mfma_f32_16x16x32_bf16 v[164:167], v[216:219], v[44:47], v[164:167]
    s_waitcnt lgkmcnt(2)
    v_mfma_f32_16x16x32_bf16 v[216:219], v[96:99], v[232:235], 0
    v_mul_f32 v208, v208, v184
    v_mul_f32 v209, v209, v185
    v_mfma_f32_16x16x32_bf16 v[220:223], v[104:107], v[232:235], 0
    v_mul_f32 v210, v210, v186
    v_mul_f32 v211, v211, v187
    v_mfma_f32_16x16x32_bf16 v[216:219], v[100:103], v[236:239], v[216:219]
    v_mul_f32 v212, v212, v200
    v_mul_f32 v213, v213, v201
    v_mfma_f32_16x16x32_bf16 v[220:223], v[108:111], v[236:239], v[220:223]
    v_mul_f32 v214, v214, v202
    v_mul_f32 v215, v215, v203
    v_cvt_pk_bf16_f32 v208, v208, v209
    v_cvt_pk_bf16_f32 v209, v210, v211
    v_cvt_pk_bf16_f32 v210, v212, v213
    v_cvt_pk_bf16_f32 v211, v214, v215
    ds_read_b128 v[232:235], v1 offset:10240
    ds_read_b128 v[236:239], v1 offset:11264
    v_mfma_f32_16x16x32_bf16 v[136:139], v[208:211], v[36:39], v[136:139]
    v_mfma_f32_16x16x32_bf16 v[152:155], v[208:211], v[40:43], v[152:155]
    v_mfma_f32_16x16x32_bf16 v[168:171], v[208:211], v[44:47], v[168:171]
    buffer_load_dwordx2 v[80:81], v240, s[28:31], 0 offen offset:384
    buffer_load_dwordx2 v[82:83], v241, s[28:31], 0 offen offset:384
    buffer_load_dwordx2 v[84:85], v242, s[28:31], 0 offen offset:384
    buffer_load_dwordx2 v[86:87], v243, s[28:31], 0 offen offset:384
    buffer_load_dwordx2 v[88:89], v244, s[28:31], 0 offen offset:384
    buffer_load_dwordx2 v[90:91], v245, s[28:31], 0 offen offset:384
    buffer_load_dwordx2 v[92:93], v246, s[28:31], 0 offen offset:384
    buffer_load_dwordx2 v[94:95], v247, s[28:31], 0 offen offset:384
    s_waitcnt lgkmcnt(2)
    v_mfma_f32_16x16x32_bf16 v[208:211], v[96:99], v[224:227], 0
    v_mul_f32 v216, v216, v188
    v_mul_f32 v217, v217, v189
    v_mfma_f32_16x16x32_bf16 v[212:215], v[104:107], v[224:227], 0
    v_mul_f32 v218, v218, v190
    v_mul_f32 v219, v219, v191
    v_mfma_f32_16x16x32_bf16 v[208:211], v[100:103], v[228:231], v[208:211]
    v_mul_f32 v220, v220, v204
    v_mul_f32 v221, v221, v205
    v_mfma_f32_16x16x32_bf16 v[212:215], v[108:111], v[228:231], v[212:215]
    v_mul_f32 v222, v222, v206
    v_mul_f32 v223, v223, v207
    v_mfma_f32_16x16x4bf16_1k v[176:191], v[22:23], v[26:27], 0 cbsz:2 abid:0
    v_mfma_f32_16x16x4bf16_1k v[192:207], v[22:23], v[26:27], 0 cbsz:2 abid:1
    v_cvt_pk_bf16_f32 v216, v216, v217
    v_cvt_pk_bf16_f32 v217, v218, v219
    v_cvt_pk_bf16_f32 v218, v220, v221
    v_cvt_pk_bf16_f32 v219, v222, v223
    ds_read_b128 v[224:227], v1 offset:12288
    ds_read_b128 v[228:231], v1 offset:13312
    v_mfma_f32_16x16x32_bf16 v[140:143], v[216:219], v[36:39], v[140:143]
    v_mfma_f32_16x16x32_bf16 v[156:159], v[216:219], v[40:43], v[156:159]
    v_mfma_f32_16x16x32_bf16 v[172:175], v[216:219], v[44:47], v[172:175]
    s_waitcnt lgkmcnt(2)
    v_mfma_f32_16x16x32_bf16 v[216:219], v[96:99], v[232:235], 0
    v_mfma_f32_16x16x32_bf16 v[220:223], v[104:107], v[232:235], 0
    v_mul_f32 v176, v208, v176
    v_mul_f32 v177, v209, v177
    v_mul_f32 v178, v210, v178
    v_mul_f32 v179, v211, v179
    v_mfma_f32_16x16x32_bf16 v[216:219], v[100:103], v[236:239], v[216:219]
    v_mul_f32 v192, v212, v192
    v_mul_f32 v193, v213, v193
    v_mfma_f32_16x16x32_bf16 v[220:223], v[108:111], v[236:239], v[220:223]
    v_mul_f32 v194, v214, v194
    v_mul_f32 v195, v215, v195
    ds_read_b128 v[232:235], v1 offset:14336
    ds_read_b128 v[236:239], v1 offset:15360
    s_waitcnt lgkmcnt(2)
    v_mfma_f32_16x16x32_bf16 v[208:211], v[96:99], v[224:227], 0
    v_mul_f32 v180, v216, v180
    v_mul_f32 v181, v217, v181
    v_mfma_f32_16x16x32_bf16 v[212:215], v[104:107], v[224:227], 0
    v_mul_f32 v182, v218, v182
    v_mul_f32 v183, v219, v183
    v_mfma_f32_16x16x32_bf16 v[208:211], v[100:103], v[228:231], v[208:211]
    v_mul_f32 v196, v220, v196
    v_mul_f32 v197, v221, v197
    v_mfma_f32_16x16x32_bf16 v[212:215], v[108:111], v[228:231], v[212:215]
    v_mul_f32 v198, v222, v198
    v_mul_f32 v199, v223, v199
    s_waitcnt lgkmcnt(0)
    v_mfma_f32_16x16x32_bf16 v[216:219], v[96:99], v[232:235], 0
    s_nop 0
    v_mul_f32 v184, v208, v184
    v_mul_f32 v185, v209, v185
    v_mfma_f32_16x16x32_bf16 v[220:223], v[104:107], v[232:235], 0
    v_mul_f32 v186, v210, v186
    v_mul_f32 v187, v211, v187
    v_mfma_f32_16x16x32_bf16 v[216:219], v[100:103], v[236:239], v[216:219]
    v_mul_f32 v200, v212, v200
    v_mul_f32 v201, v213, v201
    v_mfma_f32_16x16x32_bf16 v[220:223], v[108:111], v[236:239], v[220:223]
    v_mul_f32 v202, v214, v202
    v_mul_f32 v203, v215, v203
    s_add_u32 s70, s84, 32
    s_cmp_lt_u32 s70, s85
    s_cbranch_scc0 L2_newitem
L2_tail_toC:
    ds_read_b32 v30, v14 offset:128
    ds_read_b32 v31, v14 offset:144
    ds_read_b128 v[240:243], v4 offset:128
    ds_read_b128 v[244:247], v4 offset:144
    v_mul_f32 v188, v216, v188
    v_mul_f32 v189, v217, v189
    v_mul_f32 v190, v218, v190
    v_mul_f32 v191, v219, v191
    v_mul_f32 v204, v220, v204
    v_mul_f32 v205, v221, v205
    v_mul_f32 v206, v222, v206
    v_mul_f32 v207, v223, v207
    s_waitcnt vmcnt(16)
    v_lshlrev_b32 v224, 16, v48
    v_lshlrev_b32 v225, 16, v50
    v_lshlrev_b32 v226, 16, v52
    v_lshlrev_b32 v227, 16, v54
    v_lshlrev_b32 v228, 16, v56
    v_lshlrev_b32 v229, 16, v58
    v_lshlrev_b32 v230, 16, v60
    v_lshlrev_b32 v231, 16, v62
    v_pk_mul_f32 v[224:225], v[224:225], v[176:177]
    v_pk_mul_f32 v[226:227], v[226:227], v[178:179]
    v_pk_mul_f32 v[228:229], v[228:229], v[192:193]
    v_pk_mul_f32 v[230:231], v[230:231], v[194:195]
    v_cvt_pk_bf16_f32 v224, v224, v225
    v_cvt_pk_bf16_f32 v225, v226, v227
    v_cvt_pk_bf16_f32 v226, v228, v229
    v_cvt_pk_bf16_f32 v227, v230, v231
    v_and_b32 v232, v10, v48
    v_and_b32 v233, v10, v50
    v_mfma_f32_16x16x32_bf16 v[128:131], v[224:227], v[32:35], v[128:131]
    v_and_b32 v234, v10, v52
    v_and_b32 v235, v10, v54
    v_and_b32 v236, v10, v56
    v_and_b32 v237, v10, v58
    v_and_b32 v238, v10, v60
    v_and_b32 v239, v10, v62
    s_waitcnt lgkmcnt(0)
    v_pk_mul_f32 v[232:233], v[232:233], v[180:181]
    v_lshrrev_b32 v30, 2, v30
    v_pk_mul_f32 v[234:235], v[234:235], v[182:183]
    v_lshrrev_b32 v31, 2, v31
    v_add_u32 v30, v30, v7
    v_pk_mul_f32 v[236:237], v[236:237], v[196:197]
    v_add_u32 v31, v31, v7
    v_pk_mul_f32 v[238:239], v[238:239], v[198:199]
    v_add_u32 v240, v240, v6
    v_add_u32 v241, v241, v6
    v_cvt_pk_bf16_f32 v232, v232, v233
    v_add_u32 v242, v242, v6
    v_cvt_pk_bf16_f32 v233, v234, v235
    v_add_u32 v243, v243, v6
    v_add_u32 v244, v244, v6
    v_cvt_pk_bf16_f32 v234, v236, v237
    v_add_u32 v245, v245, v6
    v_cvt_pk_bf16_f32 v235, v238, v239
    v_add_u32 v246, v246, v6
    v_add_u32 v247, v247, v6
    buffer_load_dwordx4 v[96:99], v30, s[32:35], 0 offen offset:0
    buffer_load_dwordx4 v[100:103], v30, s[32:35], 0 offen offset:64
    buffer_load_dwordx4 v[104:107], v31, s[32:35], 0 offen offset:0
    buffer_load_dwordx4 v[108:111], v31, s[32:35], 0 offen offset:64
    v_lshlrev_b32 v208, 16, v49
    v_lshlrev_b32 v209, 16, v51
    v_mfma_f32_16x16x32_bf16 v[132:135], v[232:235], v[32:35], v[132:135]
    v_lshlrev_b32 v210, 16, v53
    v_lshlrev_b32 v211, 16, v55
    v_lshlrev_b32 v212, 16, v57
    v_lshlrev_b32 v213, 16, v59
    v_lshlrev_b32 v214, 16, v61
    v_lshlrev_b32 v215, 16, v63
    v_pk_mul_f32 v[208:209], v[208:209], v[184:185]
    v_pk_mul_f32 v[210:211], v[210:211], v[186:187]
    v_pk_mul_f32 v[212:213], v[212:213], v[200:201]
    v_pk_mul_f32 v[214:215], v[214:215], v[202:203]
    v_cvt_pk_bf16_f32 v208, v208, v209
    v_cvt_pk_bf16_f32 v209, v210, v211
    v_cvt_pk_bf16_f32 v210, v212, v213
    v_cvt_pk_bf16_f32 v211, v214, v215
    v_and_b32 v216, v10, v49
    v_and_b32 v217, v10, v51
    v_mfma_f32_16x16x32_bf16 v[136:139], v[208:211], v[32:35], v[136:139]
    v_and_b32 v218, v10, v53
    v_and_b32 v219, v10, v55
    v_and_b32 v220, v10, v57
    v_and_b32 v221, v10, v59
    v_and_b32 v222, v10, v61
    v_and_b32 v223, v10, v63
    v_pk_mul_f32 v[216:217], v[216:217], v[188:189]
    v_pk_mul_f32 v[218:219], v[218:219], v[190:191]
    v_pk_mul_f32 v[220:221], v[220:221], v[204:205]
    v_pk_mul_f32 v[222:223], v[222:223], v[206:207]
    v_cvt_pk_bf16_f32 v216, v216, v217
    v_cvt_pk_bf16_f32 v217, v218, v219
    v_cvt_pk_bf16_f32 v218, v220, v221
    v_cvt_pk_bf16_f32 v219, v222, v223
    s_waitcnt vmcnt(12)
    v_lshlrev_b32 v224, 16, v64
    v_lshlrev_b32 v225, 16, v66
    v_mfma_f32_16x16x32_bf16 v[140:143], v[216:219], v[32:35], v[140:143]
    v_lshlrev_b32 v226, 16, v68
    v_lshlrev_b32 v227, 16, v70
    v_lshlrev_b32 v228, 16, v72
    v_lshlrev_b32 v229, 16, v74
    v_lshlrev_b32 v230, 16, v76
    v_lshlrev_b32 v231, 16, v78
    v_pk_mul_f32 v[224:225], v[224:225], v[176:177]
    v_pk_mul_f32 v[226:227], v[226:227], v[178:179]
    v_pk_mul_f32 v[228:229], v[228:229], v[192:193]
    v_pk_mul_f32 v[230:231], v[230:231], v[194:195]
    v_cvt_pk_bf16_f32 v224, v224, v225
    v_cvt_pk_bf16_f32 v225, v226, v227
    v_cvt_pk_bf16_f32 v226, v228, v229
    v_cvt_pk_bf16_f32 v227, v230, v231
    v_and_b32 v232, v10, v64
    v_and_b32 v233, v10, v66
    v_mfma_f32_16x16x32_bf16 v[144:147], v[224:227], v[32:35], v[144:147]
    v_and_b32 v234, v10, v68
    v_and_b32 v235, v10, v70
    v_and_b32 v236, v10, v72
    v_and_b32 v237, v10, v74
    v_and_b32 v238, v10, v76
    v_and_b32 v239, v10, v78
    v_pk_mul_f32 v[232:233], v[232:233], v[180:181]
    v_pk_mul_f32 v[234:235], v[234:235], v[182:183]
    v_pk_mul_f32 v[236:237], v[236:237], v[196:197]
    v_pk_mul_f32 v[238:239], v[238:239], v[198:199]
    v_cvt_pk_bf16_f32 v232, v232, v233
    v_cvt_pk_bf16_f32 v233, v234, v235
    v_cvt_pk_bf16_f32 v234, v236, v237
    v_cvt_pk_bf16_f32 v235, v238, v239
    v_lshlrev_b32 v208, 16, v65
    v_lshlrev_b32 v209, 16, v67
    v_mfma_f32_16x16x32_bf16 v[148:151], v[232:235], v[32:35], v[148:151]
    v_lshlrev_b32 v210, 16, v69
    v_lshlrev_b32 v211, 16, v71
    v_lshlrev_b32 v212, 16, v73
    v_lshlrev_b32 v213, 16, v75
    v_lshlrev_b32 v214, 16, v77
    v_lshlrev_b32 v215, 16, v79
    v_pk_mul_f32 v[208:209], v[208:209], v[184:185]
    v_pk_mul_f32 v[210:211], v[210:211], v[186:187]
    v_pk_mul_f32 v[212:213], v[212:213], v[200:201]
    v_pk_mul_f32 v[214:215], v[214:215], v[202:203]
    v_cvt_pk_bf16_f32 v208, v208, v209
    v_cvt_pk_bf16_f32 v209, v210, v211
    v_cvt_pk_bf16_f32 v210, v212, v213
    v_cvt_pk_bf16_f32 v211, v214, v215
    v_and_b32 v216, v10, v65
    v_and_b32 v217, v10, v67
    v_mfma_f32_16x16x32_bf16 v[152:155], v[208:211], v[32:35], v[152:155]
    v_and_b32 v218, v10, v69
    v_and_b32 v219, v10, v71
    v_and_b32 v220, v10, v73
    v_and_b32 v221, v10, v75
    v_and_b32 v222, v10, v77
    v_and_b32 v223, v10, v79
    v_pk_mul_f32 v[216:217], v[216:217], v[188:189]
    v_pk_mul_f32 v[218:219], v[218:219], v[190:191]
    v_pk_mul_f32 v[220:221], v[220:221], v[204:205]
    v_pk_mul_f32 v[222:223], v[222:223], v[206:207]
    v_cvt_pk_bf16_f32 v216, v216, v217
    v_cvt_pk_bf16_f32 v217, v218, v219
    v_cvt_pk_bf16_f32 v218, v220, v221
    v_cvt_pk_bf16_f32 v219, v222, v223
    s_waitcnt vmcnt(4)
    v_lshlrev_b32 v224, 16, v80
    v_lshlrev_b32 v225, 16, v82
    v_mfma_f32_16x16x32_bf16 v[156:159], v[216:219], v[32:35], v[156:159]
    v_lshlrev_b32 v226, 16, v84
    v_lshlrev_b32 v227, 16, v86
    v_lshlrev_b32 v228, 16, v88
    v_lshlrev_b32 v229, 16, v90
    v_lshlrev_b32 v230, 16, v92
    v_lshlrev_b32 v231, 16, v94
    v_pk_mul_f32 v[224:225], v[224:225], v[176:177]
    v_pk_mul_f32 v[226:227], v[226:227], v[178:179]
    v_pk_mul_f32 v[228:229], v[228:229], v[192:193]
    v_pk_mul_f32 v[230:231], v[230:231], v[194:195]
    v_cvt_pk_bf16_f32 v224, v224, v225
    v_cvt_pk_bf16_f32 v225, v226, v227
    v_cvt_pk_bf16_f32 v226, v228, v229
    v_cvt_pk_bf16_f32 v227, v230, v231
    v_and_b32 v232, v10, v80
    v_and_b32 v233, v10, v82
    v_mfma_f32_16x16x32_bf16 v[160:163], v[224:227], v[32:35], v[160:163]
    v_and_b32 v234, v10, v84
    v_and_b32 v235, v10, v86
    v_and_b32 v236, v10, v88
    v_and_b32 v237, v10, v90
    v_and_b32 v238, v10, v92
    v_and_b32 v239, v10, v94
    v_pk_mul_f32 v[232:233], v[232:233], v[180:181]
    v_pk_mul_f32 v[234:235], v[234:235], v[182:183]
    v_pk_mul_f32 v[236:237], v[236:237], v[196:197]
    v_pk_mul_f32 v[238:239], v[238:239], v[198:199]
    v_cvt_pk_bf16_f32 v232, v232, v233
    v_cvt_pk_bf16_f32 v233, v234, v235
    v_cvt_pk_bf16_f32 v234, v236, v237
    v_cvt_pk_bf16_f32 v235, v238, v239
    v_lshlrev_b32 v208, 16, v81
    v_lshlrev_b32 v209, 16, v83
    v_mfma_f32_16x16x32_bf16 v[164:167], v[232:235], v[32:35], v[164:167]
    v_lshlrev_b32 v210, 16, v85
    v_lshlrev_b32 v211, 16, v87
    v_lshlrev_b32 v212, 16, v89
    v_lshlrev_b32 v213, 16, v91
    v_lshlrev_b32 v214, 16, v93
    v_lshlrev_b32 v215, 16, v95
    v_pk_mul_f32 v[208:209], v[208:209], v[184:185]
    v_pk_mul_f32 v[210:211], v[210:211], v[186:187]
    v_pk_mul_f32 v[212:213], v[212:213], v[200:201]
    v_pk_mul_f32 v[214:215], v[214:215], v[202:203]
    v_cvt_pk_bf16_f32 v208, v208, v209
    v_cvt_pk_bf16_f32 v209, v210, v211
    v_cvt_pk_bf16_f32 v210, v212, v213
    v_cvt_pk_bf16_f32 v211, v214, v215
    v_and_b32 v216, v10, v81
    v_and_b32 v217, v10, v83
    v_mfma_f32_16x16x32_bf16 v[168:171], v[208:211], v[32:35], v[168:171]
    v_and_b32 v218, v10, v85
    v_and_b32 v219, v10, v87
    v_and_b32 v220, v10, v89
    v_and_b32 v221, v10, v91
    v_and_b32 v222, v10, v93
    v_and_b32 v223, v10, v95
    v_pk_mul_f32 v[216:217], v[216:217], v[188:189]
    v_pk_mul_f32 v[218:219], v[218:219], v[190:191]
    v_pk_mul_f32 v[220:221], v[220:221], v[204:205]
    v_pk_mul_f32 v[222:223], v[222:223], v[206:207]
    v_cvt_pk_bf16_f32 v216, v216, v217
    v_cvt_pk_bf16_f32 v217, v218, v219
    v_cvt_pk_bf16_f32 v218, v220, v221
    v_cvt_pk_bf16_f32 v219, v222, v223
    s_nop 1
    v_mfma_f32_16x16x32_bf16 v[172:175], v[216:219], v[32:35], v[172:175]
    ds_read_b128 v[32:35], v5 offset:320
    ds_read_b128 v[36:39], v5 offset:448
    ds_read_b128 v[40:43], v5 offset:576
    ds_read_b128 v[44:47], v5 offset:704
    ds_read_b128 v[224:227], v1 offset:0
    ds_read_b128 v[228:231], v1 offset:1024
    ds_read_b128 v[232:235], v1 offset:2048
    ds_read_b128 v[236:239], v1 offset:3072
    s_mov_b32 s89, 0x00010001
    s_waitcnt lgkmcnt(7)
    v_xor_b32 v32, v32, v15
    v_xor_b32 v33, v33, v15
    v_xor_b32 v34, v34, v15
    v_xor_b32 v35, v35, v15
    v_mfma_f32_16x16x4bf16_1k v[176:191], v[22:23], v[24:25], 0 cbsz:2 abid:2
    v_pk_min_u16 v32, v32, s89
    v_pk_min_u16 v33, v33, s89
    v_pk_min_u16 v34, v34, s89
    v_pk_min_u16 v35, v35, s89
    v_pk_sub_u16 v32, v32, s89
    v_pk_sub_u16 v33, v33, s89
    v_pk_sub_u16 v34, v34, s89
    v_pk_sub_u16 v35, v35, s89
    v_mfma_f32_16x16x4bf16_1k v[192:207], v[22:23], v[24:25], 0 cbsz:2 abid:3
    s_waitcnt lgkmcnt(4)
    v_and_b32 v36, v36, v32
    v_and_b32 v37, v37, v33
    v_and_b32 v38, v38, v34
    v_and_b32 v39, v39, v35
    v_and_b32 v40, v40, v32
    v_and_b32 v41, v41, v33
    v_and_b32 v42, v42, v34
    v_and_b32 v43, v43, v35
    v_and_b32 v44, v44, v32
    v_and_b32 v45, v45, v33
    v_and_b32 v46, v46, v34
    v_and_b32 v47, v47, v35
    v_and_b32 v32, 0x3f803f80, v32
    v_and_b32 v33, 0x3f803f80, v33
    v_and_b32 v34, 0x3f803f80, v34
    v_and_b32 v35, 0x3f803f80, v35
    buffer_load_dwordx2 v[48:49], v240, s[28:31], 0 offen offset:128
    buffer_load_dwordx2 v[50:51], v241, s[28:31], 0 offen offset:128
    buffer_load_dwordx2 v[52:53], v242, s[28:31], 0 offen offset:128
    buffer_load_dwordx2 v[54:55], v243, s[28:31], 0 offen offset:128
    buffer_load_dwordx2 v[56:57], v244, s[28:31], 0 offen offset:128
    buffer_load_dwordx2 v[58:59], v245, s[28:31], 0 offen offset:128
    buffer_load_dwordx2 v[60:61], v246, s[28:31], 0 offen offset:128
    buffer_load_dwordx2 v[62:63], v247, s[28:31], 0 offen offset:128
    s_waitcnt vmcnt(8)
    s_waitcnt lgkmcnt(2)
    v_mfma_f32_16x16x32_bf16 v[208:211], v[96:99], v[224:227], 0
    v_mfma_f32_16x16x32_bf16 v[212:215], v[104:107], v[224:227], 0
    v_mfma_f32_16x16x32_bf16 v[208:211], v[100:103], v[228:231], v[208:211]
    v_mfma_f32_16x16x32_bf16 v[212:215], v[108:111], v[228:231], v[212:215]
    ds_read_b128 v[224:227], v1 offset:4096
    ds_read_b128 v[228:231], v1 offset:5120
    s_waitcnt lgkmcnt(2)
    v_mfma_f32_16x16x32_bf16 v[216:219], v[96:99], v[232:235], 0
    s_nop 2
    v_mul_f32 v208, v208, v176
    v_mul_f32 v209, v209, v177
    v_mfma_f32_16x16x32_bf16 v[220:223], v[104:107], v[232:235], 0
    v_mul_f32 v210, v210, v178
    v_mul_f32 v211, v211, v179
    v_mfma_f32_16x16x32_bf16 v[216:219], v[100:103], v[236:239], v[216:219]
    v_mul_f32 v212, v212, v192
    v_mul_f32 v213, v213, v193
    v_mfma_f32_16x16x32_bf16 v[220:223], v[108:111], v[236:239], v[220:223]
    v_mul_f32 v214, v214, v194
    v_mul_f32 v215, v215, v195
    v_cvt_pk_bf16_f32 v208, v208, v209
    v_cvt_pk_bf16_f32 v209, v210, v211
    v_cvt_pk_bf16_f32 v210, v212, v213
    v_cvt_pk_bf16_f32 v211, v214, v215
    ds_read_b128 v[232:235], v1 offset:6144
    ds_read_b128 v[236:239], v1 offset:7168
    v_mfma_f32_16x16x32_bf16 v[112:115], v[208:211], v[32:35], v[112:115]
    s_waitcnt lgkmcnt(2)
    v_mfma_f32_16x16x32_bf16 v[208:211], v[96:99], v[224:227], 0
    v_mul_f32 v216, v216, v180
    v_mul_f32 v217, v217, v181
    v_mfma_f32_16x16x32_bf16 v[212:215], v[104:107], v[224:227], 0
    v_mul_f32 v218, v218, v182
    v_mul_f32 v219, v219, v183
    v_mfma_f32_16x16x32_bf16 v[208:211], v[100:103], v[228:231], v[208:211]
    v_mul_f32 v220, v220, v196
    v_mul_f32 v221, v221, v197
    v_mfma_f32_16x16x32_bf16 v[212:215], v[108:111], v[228:231], v[212:215]
    v_mul_f32 v222, v222, v198
    v_mul_f32 v223, v223, v199
    v_cvt_pk_bf16_f32 v216, v216, v217
    v_cvt_pk_bf16_f32 v217, v218, v219
    v_cvt_pk_bf16_f32 v218, v220, v221
    v_cvt_pk_bf16_f32 v219, v222, v223
    ds_read_b128 v[224:227], v1 offset:16384
    ds_read_b128 v[228:231], v1 offset:17408
    v_mfma_f32_16x16x32_bf16 v[116:119], v[216:219], v[32:35], v[116:119]
    s_waitcnt lgkmcnt(2)
    v_mfma_f32_16x16x32_bf16 v[216:219], v[96:99], v[232:235], 0
    v_mul_f32 v208, v208, v184
    v_mul_f32 v209, v209, v185
    v_mfma_f32_16x16x32_bf16 v[220:223], v[104:107], v[232:235], 0
    v_mul_f32 v210, v210, v186
    v_mul_f32 v211, v211, v187
    v_mfma_f32_16x16x32_bf16 v[216:219], v[100:103], v[236:239], v[216:219]
    v_mul_f32 v212, v212, v200
    v_mul_f32 v213, v213, v201
    v_mfma_f32_16x16x32_bf16 v[220:223], v[108:111], v[236:239], v[220:223]
    v_mul_f32 v214, v214, v202
    v_mul_f32 v215, v215, v203
    v_cvt_pk_bf16_f32 v208, v208, v209
    v_cvt_pk_bf16_f32 v209, v210, v211
    v_cvt_pk_bf16_f32 v210, v212, v213
    v_cvt_pk_bf16_f32 v211, v214, v215
    ds_read_b128 v[232:235], v1 offset:18432
    ds_read_b128 v[236:239], v1 offset:19456
    v_mfma_f32_16x16x32_bf16 v[120:123], v[208:211], v[32:35], v[120:123]
    buffer_load_dwordx2 v[64:65], v240, s[28:31], 0 offen offset:256
    buffer_load_dwordx2 v[66:67], v241, s[28:31], 0 offen offset:256
    buffer_load_dwordx2 v[68:69], v242, s[28:31], 0 offen offset:256
    buffer_load_dwordx2 v[70:71], v243, s[28:31], 0 offen offset:256
    buffer_load_dwordx2 v[72:73], v244, s[28:31], 0 offen offset:256
    buffer_load_dwordx2 v[74:75], v245, s[28:31], 0 offen offset:256
    buffer_load_dwordx2 v[76:77], v246, s[28:31], 0 offen offset:256
    buffer_load_dwordx2 v[78:79], v247, s[28:31], 0 offen offset:256
    s_waitcnt lgkmcnt(2)
    v_mfma_f32_16x16x32_bf16 v[208:211], v[96:99], v[224:227], 0
    v_mul_f32 v216, v216, v188
    v_mul_f32 v217, v217, v189
    v_mfma_f32_16x16x32_bf16 v[212:215], v[104:107], v[224:227], 0
    v_mul_f32 v218, v218, v190
    v_mul_f32 v219, v219, v191
    v_mfma_f32_16x16x32_bf16 v[208:211], v[100:103], v[228:231], v[208:211]
    v_mul_f32 v220, v220, v204
    v_mul_f32 v221, v221, v205
    v_mfma_f32_16x16x32_bf16 v[212:215], v[108:111], v[228:231], v[212:215]
    v_mul_f32 v222, v222, v206
    v_mul_f32 v223, v223, v207
    v_mfma_f32_16x16x4bf16_1k v[176:191], v[22:23], v[28:29], 0 cbsz:2 abid:2
    v_mfma_f32_16x16x4bf16_1k v[192:207], v[22:23], v[28:29], 0 cbsz:2 abid:3
    v_cvt_pk_bf16_f32 v216, v216, v217
    v_cvt_pk_bf16_f32 v217, v218, v219
    v_cvt_pk_bf16_f32 v218, v220, v221
    v_cvt_pk_bf16_f32 v219, v222, v223
    ds_read_b128 v[224:227], v1 offset:20480
    ds_read_b128 v[228:231], v1 offset:21504
    v_mfma_f32_16x16x32_bf16 v[124:127], v[216:219], v[32:35], v[124:127]
    s_waitcnt lgkmcnt(2)
    v_mfma_f32_16x16x32_bf16 v[216:219], v[96:99], v[232:235], 0
    v_mfma_f32_16x16x32_bf16 v[220:223], v[104:107], v[232:235], 0
    s_nop 0
    v_mul_f32 v208, v208, v176
    v_mul_f32 v209, v209, v177
    v_mul_f32 v210, v210, v178
    v_mul_f32 v211, v211, v179
    v_mfma_f32_16x16x32_bf16 v[216:219], v[100:103], v[236:239], v[216:219]
    v_mul_f32 v212, v212, v192
    v_mul_f32 v213, v213, v193
    v_mfma_f32_16x16x32_bf16 v[220:223], v[108:111], v[236:239], v[220:223]
    v_mul_f32 v214, v214, v194
    v_mul_f32 v215, v215, v195
    v_cvt_pk_bf16_f32 v208, v208, v209
    v_cvt_pk_bf16_f32 v209, v210, v211
    v_cvt_pk_bf16_f32 v210, v212, v213
    v_cvt_pk_bf16_f32 v211, v214, v215
    ds_read_b128 v[232:235], v1 offset:22528
    ds_read_b128 v[236:239], v1 offset:23552
    v_mfma_f32_16x16x32_bf16 v[128:131], v[208:211], v[36:39], v[128:131]
    v_mfma_f32_16x16x32_bf16 v[144:147], v[208:211], v[40:43], v[144:147]
    v_mfma_f32_16x16x32_bf16 v[160:163], v[208:211], v[44:47], v[160:163]
    s_waitcnt lgkmcnt(2)
    v_mfma_f32_16x16x32_bf16 v[208:211], v[96:99], v[224:227], 0
    v_mul_f32 v216, v216, v180
    v_mul_f32 v217, v217, v181
    v_mfma_f32_16x16x32_bf16 v[212:215], v[104:107], v[224:227], 0
    v_mul_f32 v218, v218, v182
    v_mul_f32 v219, v219, v183
    v_mfma_f32_16x16x32_bf16 v[208:211], v[100:103], v[228:231], v[208:211]
    v_mul_f32 v220, v220, v196
    v_mul_f32 v221, v221, v197
    v_mfma_f32_16x16x32_bf16 v[212:215], v[108:111], v[228:231], v[212:215]
    v_mul_f32 v222, v222, v198
    v_mul_f32 v223, v223, v199
    v_cvt_pk_bf16_f32 v216, v216, v217
    v_cvt_pk_bf16_f32 v217, v218, v219
    v_cvt_pk_bf16_f32 v218, v220, v221
    v_cvt_pk_bf16_f32 v219, v222, v223
    ds_read_b128 v[224:227], v1 offset:8192
    ds_read_b128 v[228:231], v1 offset:9216
    v_mfma_f32_16x16x32_bf16 v[132:135], v[216:219], v[36:39], v[132:135]
    v_mfma_f32_16x16x32_bf16 v[148:151], v[216:219], v[40:43], v[148:151]
    v_mfma_f32_16x16x32_bf16 v[164:167], v[216:219], v[44:47], v[164:167]
    s_waitcnt lgkmcnt(2)
    v_mfma_f32_16x16x32_bf16 v[216:219], v[96:99], v[232:235], 0
    v_mul_f32 v208, v208, v184
    v_mul_f32 v209, v209, v185
    v_mfma_f32_16x16x32_bf16 v[220:223], v[104:107], v[232:235], 0
    v_mul_f32 v210, v210, v186
    v_mul_f32 v211, v211, v187
    v_mfma_f32_16x16x32_bf16 v[216:219], v[100:103], v[236:239], v[216:219]
    v_mul_f32 v212, v212, v200
    v_mul_f32 v213, v213, v201
    v_mfma_f32_16x16x32_bf16 v[220:223], v[108:111], v[236:239], v[220:223]
    v_mul_f32 v214, v214, v202
    v_mul_f32 v215, v215, v203
    v_cvt_pk_bf16_f32 v208, v208, v209
    v_cvt_pk_bf16_f32 v209, v210, v211
    v_cvt_pk_bf16_f32 v210, v212, v213
    v_cvt_pk_bf16_f32 v211, v214, v215
    ds_read_b128 v[232:235], v1 offset:10240
    ds_read_b128 v[236:239], v1 offset:11264
    v_mfma_f32_16x16x32_bf16 v[136:139], v[208:211], v[36:39], v[136:139]
    v_mfma_f32_16x16x32_bf16 v[152:155], v[208:211], v[40:43], v[152:155]
    v_mfma_f32_16x16x32_bf16 v[168:171], v[208:211], v[44:47], v[168:171]
    buffer_load_dwordx2 v[80:81], v240, s[28:31], 0 offen offset:384
    buffer_load_dwordx2 v[82:83], v241, s[28:31], 0 offen offset:384
    buffer_load_dwordx2 v[84:85], v242, s[28:31], 0 offen offset:384
    buffer_load_dwordx2 v[86:87], v243, s[28:31], 0 offen offset:384
    buffer_load_dwordx2 v[88:89], v244, s[28:31], 0 offen offset:384
    buffer_load_dwordx2 v[90:91], v245, s[28:31], 0 offen offset:384
    buffer_load_dwordx2 v[92:93], v246, s[28:31], 0 offen offset:384
    buffer_load_dwordx2 v[94:95], v247, s[28:31], 0 offen offset:384
    s_waitcnt lgkmcnt(2)
    v_mfma_f32_16x16x32_bf16 v[208:211], v[96:99], v[224:227], 0
    v_mul_f32 v216, v216, v188
    v_mul_f32 v217, v217, v189
    v_mfma_f32_16x16x32_bf16 v[212:215], v[104:107], v[224:227], 0
    v_mul_f32 v218, v218, v190
    v_mul_f32 v219, v219, v191
    v_mfma_f32_16x16x32_bf16 v[208:211], v[100:103], v[228:231], v[208:211]
    v_mul_f32 v220, v220, v204
    v_mul_f32 v221, v221, v205
    v_mfma_f32_16x16x32_bf16 v[212:215], v[108:111], v[228:231], v[212:215]
    v_mul_f32 v222, v222, v206
    v_mul_f32 v223, v223, v207
    v_mfma_f32_16x16x4bf16_1k v[176:191], v[22:23], v[26:27], 0 cbsz:2 abid:2
    v_mfma_f32_16x16x4bf16_1k v[192:207], v[22:23], v[26:27], 0 cbsz:2 abid:3
    v_cvt_pk_bf16_f32 v216, v216, v217
    v_cvt_pk_bf16_f32 v217, v218, v219
    v_cvt_pk_bf16_f32 v218, v220, v221
    v_cvt_pk_bf16_f32 v219, v222, v223
    ds_read_b128 v[224:227], v1 offset:12288
    ds_read_b128 v[228:231], v1 offset:13312
    v_mfma_f32_16x16x32_bf16 v[140:143], v[216:219], v[36:39], v[140:143]
    v_mfma_f32_16x16x32_bf16 v[156:159], v[216:219], v[40:43], v[156:159]
    v_mfma_f32_16x16x32_bf16 v[172:175], v[216:219], v[44:47], v[172:175]
    s_waitcnt lgkmcnt(2)
    v_mfma_f32_16x16x32_bf16 v[216:219], v[96:99], v[232:235], 0
    v_mfma_f32_16x16x32_bf16 v[220:223], v[104:107], v[232:235], 0
    v_mul_f32 v176, v208, v176
    v_mul_f32 v177, v209, v177
    v_mul_f32 v178, v210, v178
    v_mul_f32 v179, v211, v179
    v_mfma_f32_16x16x32_bf16 v[216:219], v[100:103], v[236:239], v[216:219]
    v_mul_f32 v192, v212, v192
    v_mul_f32 v193, v213, v193
    v_mfma_f32_16x16x32_bf16 v[220:223], v[108:111], v[236:239], v[220:223]
    v_mul_f32 v194, v214, v194
    v_mul_f32 v195, v215, v195
    ds_read_b128 v[232:235], v1 offset:14336
    ds_read_b128 v[236:239], v1 offset:15360
    s_waitcnt lgkmcnt(2)
    v_mfma_f32_16x16x32_bf16 v[208:211], v[96:99], v[224:227], 0
    v_mul_f32 v180, v216, v180
    v_mul_f32 v181, v217, v181
    v_mfma_f32_16x16x32_bf16 v[212:215], v[104:107], v[224:227], 0
    v_mul_f32 v182, v218, v182
    v_mul_f32 v183, v219, v183
    v_mfma_f32_16x16x32_bf16 v[208:211], v[100:103], v[228:231], v[208:211]
    v_mul_f32 v196, v220, v196
    v_mul_f32 v197, v221, v197
    v_mfma_f32_16x16x32_bf16 v[212:215], v[108:111], v[228:231], v[212:215]
    v_mul_f32 v198, v222, v198
    v_mul_f32 v199, v223, v199
    s_waitcnt lgkmcnt(0)
    v_mfma_f32_16x16x32_bf16 v[216:219], v[96:99], v[232:235], 0
    s_nop 0
    v_mul_f32 v184, v208, v184
    v_mul_f32 v185, v209, v185
    v_mfma_f32_16x16x32_bf16 v[220:223], v[104:107], v[232:235], 0
    v_mul_f32 v186, v210, v186
    v_mul_f32 v187, v211, v187
    v_mfma_f32_16x16x32_bf16 v[216:219], v[100:103], v[236:239], v[216:219]
    v_mul_f32 v200, v212, v200
    v_mul_f32 v201, v213, v201
    v_mfma_f32_16x16x32_bf16 v[220:223], v[108:111], v[236:239], v[220:223]
    v_mul_f32 v202, v214, v202
    v_mul_f32 v203, v215, v203
    s_add_u32 s70, s84, 64
    s_cmp_lt_u32 s70, s85
    s_cbranch_scc0 L2_newitem
    s_mov_b32 s71, s85
    s_mov_b32 s68, s63
    s_mov_b32 s69, s26
    s_mov_b32 s72, 1
    s_mov_b32 s73, 0
    s_branch L2_tail_toA
L2_newitem:
    s_mov_b32 s73, 1
    s_cmp_eq_u32 s61, 0
    s_cbranch_scc1 L2_walkdone1
L2_walk1:
    v_readlane_b32 s89, v13, s60
    s_lshr_b32 s90, s60, 2
    s_and_b32 s90, s90, 16
    s_lshr_b32 s89, s89, s90
    s_and_b32 s60, s89, 0xffff
    s_sub_u32 s61, s61, 1
    s_cmp_lg_u32 s61, 0
    s_cbranch_scc1 L2_walk1
L2_walkdone1:
    s_cmp_eq_u32 s62, 0
    s_cbranch_scc1 L2_walkdone2
L2_walk2:
    v_readlane_b32 s89, v18, s60
    s_lshr_b32 s90, s60, 2
    s_and_b32 s90, s90, 16
    s_lshr_b32 s89, s89, s90
    s_and_b32 s60, s89, 0xffff
    s_sub_u32 s62, s62, 1
    s_cmp_lg_u32 s62, 0
    s_cbranch_scc1 L2_walk2
L2_walkdone2:
    s_cmp_ge_u32 s60, 100
    s_cbranch_scc1 L2_tail_fin
    s_cmp_eq_u32 s76, 0
    s_cbranch_scc1 L2_nomode0
    v_readlane_b32 s89, v12, s60
    s_lshr_b32 s90, s60, 2
    s_and_b32 s90, s90, 16
    s_lshr_b32 s89, s89, s90
    s_and_b32 s91, s89, 0xffff
    s_sub_u32 s91, s79, s91
    s_cmp_gt_u32 s91, 54
    s_cbranch_scc0 L2_small0
    v_mov_b32 v13, v18
    s_nop 1
    s_branch L2_nomode0
L2_small0:
    v_and_b32 v248, 0xffff, v12
    v_lshrrev_b32 v249, 16, v12
    v_add_u32 v248, 16, v248
    v_add_u32 v249, 16, v249
    v_lshlrev_b32 v250, 2, v248
    v_lshlrev_b32 v251, 2, v249
    ds_read_b32 v250, v250 offset:33824
    ds_read_b32 v251, v251 offset:33824
    v_cmp_gt_u32 s[64:65], s79, v248
    v_cmp_gt_u32 s[66:67], s79, v249
    v_mov_b32 v254, 100
    v_lshrrev_b32 v255, 4, v1
    s_waitcnt lgkmcnt(0)
    v_and_b32 v250, 127, v250
    v_cndmask_b32_e64 v250, v254, v250, s[64:65]
    v_add_u32 v248, 1, v255
    v_add_u32 v249, 16, v255
    v_med3_u32 v250, v250, v248, v249
    v_min_u32 v250, v254, v250
    v_and_b32 v251, 127, v251
    v_cndmask_b32_e64 v251, v254, v251, s[66:67]
    v_add_u32 v248, 65, v255
    v_add_u32 v249, 80, v255
    v_med3_u32 v251, v251, v248, v249
    v_min_u32 v251, v254, v251
    v_lshl_or_b32 v13, v251, 16, v250
    s_nop 1
L2_nomode0:
    s_cmp_eq_u32 s74, 0
    s_cbranch_scc1 L2_walkdone3
L2_walk3:
    v_readlane_b32 s89, v13, s60
    s_lshr_b32 s90, s60, 2
    s_and_b32 s90, s90, 16
    s_lshr_b32 s89, s89, s90
    s_and_b32 s60, s89, 0xffff
    s_sub_u32 s74, s74, 1
    s_cmp_lg_u32 s74, 0
    s_cbranch_scc1 L2_walk3
L2_walkdone3:
    s_cmp_eq_u32 s75, 0
    s_cbranch_scc1 L2_walkdone4
L2_walk4:
    v_readlane_b32 s89, v18, s60
    s_lshr_b32 s90, s60, 2
    s_and_b32 s90, s90, 16
    s_lshr_b32 s89, s89, s90
    s_and_b32 s60, s89, 0xffff
    s_sub_u32 s75, s75, 1
    s_cmp_lg_u32 s75, 0
    s_cbranch_scc1 L2_walk4
L2_walkdone4:
    s_cmp_ge_u32 s60, 100
    s_cbranch_scc1 L2_tail_fin
    s_mov_b32 s68, s60
    v_readlane_b32 s89, v12, s60
    s_lshr_b32 s90, s60, 2
    s_and_b32 s90, s90, 16
    s_lshr_b32 s89, s89, s90
    s_and_b32 s70, s89, 0xffff
    s_cmp_eq_u32 s77, 0
    s_cbranch_scc1 L2_end32_0
    v_readlane_b32 s89, v13, s60
    s_lshr_b32 s90, s60, 2
    s_and_b32 s90, s90, 16
    s_lshr_b32 s89, s89, s90
    s_and_b32 s60, s89, 0xffff
    s_branch L2_ended0
L2_end32_0:
    v_readlane_b32 s89, v18, s60
    s_lshr_b32 s90, s60, 2
    s_and_b32 s90, s90, 16
    s_lshr_b32 s89, s89, s90
    s_and_b32 s60, s89, 0xffff
L2_ended0:
    v_readlane_b32 s89, v12, s60
    s_lshr_b32 s90, s60, 2
    s_and_b32 s90, s90, 16
    s_lshr_b32 s89, s89, s90
    s_and_b32 s71, s89, 0xffff
    s_mov_b32 s77, 0
    s_cmp_lg_u32 s78, 0
    s_cbranch_scc1 L2_later0
    s_mov_b32 s78, 1
    s_mov_b32 s75, s3
    s_xor_b32 s76, s76, 1
    s_sub_u32 s89, 3, s3
    s_max_i32 s62, s89, 0
    s_sub_u32 s89, 7, s3
    s_min_u32 s74, s89, 4
    s_branch L2_walked0
L2_later0:
    s_mov_b32 s62, 7
    s_mov_b32 s76, 0
L2_walked0:
    s_sub_u32 s69, s60, s68
    s_mov_b32 s72, 0
L2_tail_toA:
    s_lshl_b32 s89, s70, 2
    v_lshrrev_b32 v249, 2, v1
    v_add_u32 v248, s89, v249
    ds_read_b32 v17, v248 offset:33824
    s_sub_u32 s89, s71, s70
    s_lshl_b32 s89, s89, 2
    v_subrev_u32 v252, s89, v249
    v_ashrrev_i32 v252, 31, v252
    s_setprio 1
    v_mul_f32 v188, v216, v188
    v_mul_f32 v189, v217, v189
    v_mul_f32 v190, v218, v190
    v_mul_f32 v191, v219, v191
    v_mul_f32 v204, v220, v204
    v_mul_f32 v205, v221, v205
    v_mul_f32 v206, v222, v206
    v_mul_f32 v207, v223, v207
    s_waitcnt vmcnt(16)
    v_lshlrev_b32 v224, 16, v48
    v_lshlrev_b32 v225, 16, v50
    v_lshlrev_b32 v226, 16, v52
    v_lshlrev_b32 v227, 16, v54
    v_lshlrev_b32 v228, 16, v56
    v_lshlrev_b32 v229, 16, v58
    v_lshlrev_b32 v230, 16, v60
    v_lshlrev_b32 v231, 16, v62
    v_pk_mul_f32 v[224:225], v[224:225], v[176:177]
    v_pk_mul_f32 v[226:227], v[226:227], v[178:179]
    v_pk_mul_f32 v[228:229], v[228:229], v[192:193]
    v_pk_mul_f32 v[230:231], v[230:231], v[194:195]
    v_cvt_pk_bf16_f32 v224, v224, v225
    v_cvt_pk_bf16_f32 v225, v226, v227
    v_cvt_pk_bf16_f32 v226, v228, v229
    v_cvt_pk_bf16_f32 v227, v230, v231
    v_and_b32 v232, v10, v48
    v_and_b32 v233, v10, v50
    v_mfma_f32_16x16x32_bf16 v[128:131], v[224:227], v[32:35], v[128:131]
    v_and_b32 v234, v10, v52
    v_and_b32 v235, v10, v54
    v_and_b32 v236, v10, v56
    v_and_b32 v237, v10, v58
    v_and_b32 v238, v10, v60
    v_and_b32 v239, v10, v62
    s_waitcnt lgkmcnt(0)
    v_pk_mul_f32 v[232:233], v[232:233], v[180:181]
    v_bitop3_b32 v17, v17, v252, v252 bitop3:0xf3
    v_pk_mul_f32 v[234:235], v[234:235], v[182:183]
    v_and_b32 v252, 0x7ffffe00, v17
    v_pk_mul_f32 v[236:237], v[236:237], v[196:197]
    v_lshrrev_b32 v253, 9, v17
    v_pk_mul_f32 v[238:239], v[238:239], v[198:199]
    ds_write_b32 v2, v252
    v_cvt_pk_bf16_f32 v232, v232, v233
    v_mul_u32_u24 v253, 6, v253
    v_cvt_pk_bf16_f32 v233, v234, v235
    ds_read_b32 v30, v14 offset:0
    v_cvt_pk_bf16_f32 v234, v236, v237
    ds_read_b32 v31, v14 offset:16
    v_cvt_pk_bf16_f32 v235, v238, v239
    ds_read_b128 v[240:243], v4 offset:0
    ds_read_b128 v[244:247], v4 offset:16
    v_lshlrev_b32 v208, 16, v49
    v_lshlrev_b32 v209, 16, v51
    v_mfma_f32_16x16x32_bf16 v[132:135], v[232:235], v[32:35], v[132:135]
    v_lshlrev_b32 v210, 16, v53
    v_lshlrev_b32 v211, 16, v55
    v_lshlrev_b32 v212, 16, v57
    v_lshlrev_b32 v213, 16, v59
    v_lshlrev_b32 v214, 16, v61
    v_lshlrev_b32 v215, 16, v63
    v_pk_mul_f32 v[208:209], v[208:209], v[184:185]
    v_pk_mul_f32 v[210:211], v[210:211], v[186:187]
    v_pk_mul_f32 v[212:213], v[212:213], v[200:201]
    v_pk_mul_f32 v[214:215], v[214:215], v[202:203]
    v_cvt_pk_bf16_f32 v208, v208, v209
    v_cvt_pk_bf16_f32 v209, v210, v211
    v_cvt_pk_bf16_f32 v210, v212, v213
    v_cvt_pk_bf16_f32 v211, v214, v215
    v_and_b32 v216, v10, v49
    v_and_b32 v217, v10, v51
    v_mfma_f32_16x16x32_bf16 v[136:139], v[208:211], v[32:35], v[136:139]
    v_and_b32 v218, v10, v53
    v_and_b32 v219, v10, v55
    v_and_b32 v220, v10, v57
    v_and_b32 v221, v10, v59
    v_and_b32 v222, v10, v61
    v_and_b32 v223, v10, v63
    s_waitcnt lgkmcnt(0)
    v_pk_mul_f32 v[216:217], v[216:217], v[188:189]
    v_lshrrev_b32 v30, 2, v30
    v_pk_mul_f32 v[218:219], v[218:219], v[190:191]
    v_lshrrev_b32 v31, 2, v31
    v_add_u32 v30, v30, v7
    v_pk_mul_f32 v[220:221], v[220:221], v[204:205]
    v_add_u32 v31, v31, v7
    v_pk_mul_f32 v[222:223], v[222:223], v[206:207]
    v_add_u32 v240, v240, v6
    v_add_u32 v241, v241, v6
    v_cvt_pk_bf16_f32 v216, v216, v217
    v_add_u32 v242, v242, v6
    v_cvt_pk_bf16_f32 v217, v218, v219
    v_add_u32 v243, v243, v6
    v_add_u32 v244, v244, v6
    v_cvt_pk_bf16_f32 v218, v220, v221
    v_add_u32 v245, v245, v6
    v_cvt_pk_bf16_f32 v219, v222, v223
    v_add_u32 v246, v246, v6
    v_add_u32 v247, v247, v6
    v_and_b32 v252, -4, v253
    buffer_load_dwordx2 v[20:21], v252, s[36:39], 0 offen
    buffer_load_dwordx4 v[96:99], v30, s[32:35], 0 offen offset:0
    buffer_load_dwordx4 v[100:103], v30, s[32:35], 0 offen offset:64
    buffer_load_dwordx4 v[104:107], v31, s[32:35], 0 offen offset:0
    buffer_load_dwordx4 v[108:111], v31, s[32:35], 0 offen offset:64
    s_waitcnt vmcnt(13)
    v_lshlrev_b32 v224, 16, v64
    v_lshlrev_b32 v225, 16, v66
    v_mfma_f32_16x16x32_bf16 v[140:143], v[216:219], v[32:35], v[140:143]
    v_lshlrev_b32 v226, 16, v68
    v_lshlrev_b32 v227, 16, v70
    v_lshlrev_b32 v228, 16, v72
    v_lshlrev_b32 v229, 16, v74
    v_lshlrev_b32 v230, 16, v76
    v_lshlrev_b32 v231, 16, v78
    v_pk_mul_f32 v[224:225], v[224:225], v[176:177]
    v_pk_mul_f32 v[226:227], v[226:227], v[178:179]
    v_pk_mul_f32 v[228:229], v[228:229], v[192:193]
    v_pk_mul_f32 v[230:231], v[230:231], v[194:195]
    v_cvt_pk_bf16_f32 v224, v224, v225
    v_cvt_pk_bf16_f32 v225, v226, v227
    v_cvt_pk_bf16_f32 v226, v228, v229
    v_cvt_pk_bf16_f32 v227, v230, v231
    v_and_b32 v232, v10, v64
    v_and_b32 v233, v10, v66
    v_mfma_f32_16x16x32_bf16 v[144:147], v[224:227], v[32:35], v[144:147]
    v_and_b32 v234, v10, v68
    v_and_b32 v235, v10, v70
    v_and_b32 v236, v10, v72
    v_and_b32 v237, v10, v74
    v_and_b32 v238, v10, v76
    v_and_b32 v239, v10, v78
    v_pk_mul_f32 v[232:233], v[232:233], v[180:181]
    v_pk_mul_f32 v[234:235], v[234:235], v[182:183]
    v_pk_mul_f32 v[236:237], v[236:237], v[196:197]
    v_pk_mul_f32 v[238:239], v[238:239], v[198:199]
    v_cvt_pk_bf16_f32 v232, v232, v233
    v_cvt_pk_bf16_f32 v233, v234, v235
    v_cvt_pk_bf16_f32 v234, v236, v237
    v_cvt_pk_bf16_f32 v235, v238, v239
    v_lshlrev_b32 v208, 16, v65
    v_lshlrev_b32 v209, 16, v67
    v_mfma_f32_16x16x32_bf16 v[148:151], v[232:235], v[32:35], v[148:151]
    v_lshlrev_b32 v210, 16, v69
    v_lshlrev_b32 v211, 16, v71
    v_lshlrev_b32 v212, 16, v73
    v_lshlrev_b32 v213, 16, v75
    v_lshlrev_b32 v214, 16, v77
    v_lshlrev_b32 v215, 16, v79
    v_pk_mul_f32 v[208:209], v[208:209], v[184:185]
    v_pk_mul_f32 v[210:211], v[210:211], v[186:187]
    v_pk_mul_f32 v[212:213], v[212:213], v[200:201]
    v_pk_mul_f32 v[214:215], v[214:215], v[202:203]
    v_cvt_pk_bf16_f32 v208, v208, v209
    v_cvt_pk_bf16_f32 v209, v210, v211
    v_cvt_pk_bf16_f32 v210, v212, v213
    v_cvt_pk_bf16_f32 v211, v214, v215
    v_and_b32 v216, v10, v65
    v_and_b32 v217, v10, v67
    v_mfma_f32_16x16x32_bf16 v[152:155], v[208:211], v[32:35], v[152:155]
    v_and_b32 v218, v10, v69
    v_and_b32 v219, v10, v71
    v_and_b32 v220, v10, v73
    v_and_b32 v221, v10, v75
    v_and_b32 v222, v10, v77
    v_and_b32 v223, v10, v79
    v_pk_mul_f32 v[216:217], v[216:217], v[188:189]
    v_pk_mul_f32 v[218:219], v[218:219], v[190:191]
    v_pk_mul_f32 v[220:221], v[220:221], v[204:205]
    v_pk_mul_f32 v[222:223], v[222:223], v[206:207]
    v_cvt_pk_bf16_f32 v216, v216, v217
    v_cvt_pk_bf16_f32 v217, v218, v219
    v_cvt_pk_bf16_f32 v218, v220, v221
    v_cvt_pk_bf16_f32 v219, v222, v223
    s_waitcnt vmcnt(5)
    v_lshlrev_b32 v224, 16, v80
    v_lshlrev_b32 v225, 16, v82
    v_mfma_f32_16x16x32_bf16 v[156:159], v[216:219], v[32:35], v[156:159]
    v_lshlrev_b32 v226, 16, v84
    v_lshlrev_b32 v227, 16, v86
    v_lshlrev_b32 v228, 16, v88
    v_lshlrev_b32 v229, 16, v90
    v_lshlrev_b32 v230, 16, v92
    v_lshlrev_b32 v231, 16, v94
    v_pk_mul_f32 v[224:225], v[224:225], v[176:177]
    v_pk_mul_f32 v[226:227], v[226:227], v[178:179]
    v_pk_mul_f32 v[228:229], v[228:229], v[192:193]
    v_pk_mul_f32 v[230:231], v[230:231], v[194:195]
    v_cvt_pk_bf16_f32 v224, v224, v225
    v_cvt_pk_bf16_f32 v225, v226, v227
    v_cvt_pk_bf16_f32 v226, v228, v229
    v_cvt_pk_bf16_f32 v227, v230, v231
    v_and_b32 v232, v10, v80
    v_and_b32 v233, v10, v82
    v_mfma_f32_16x16x32_bf16 v[160:163], v[224:227], v[32:35], v[160:163]
    v_and_b32 v234, v10, v84
    v_and_b32 v235, v10, v86
    v_and_b32 v236, v10, v88
    v_and_b32 v237, v10, v90
    v_and_b32 v238, v10, v92
    v_and_b32 v239, v10, v94
    v_pk_mul_f32 v[232:233], v[232:233], v[180:181]
    v_pk_mul_f32 v[234:235], v[234:235], v[182:183]
    v_pk_mul_f32 v[236:237], v[236:237], v[196:197]
    v_pk_mul_f32 v[238:239], v[238:239], v[198:199]
    v_cvt_pk_bf16_f32 v232, v232, v233
    v_cvt_pk_bf16_f32 v233, v234, v235
    v_cvt_pk_bf16_f32 v234, v236, v237
    v_cvt_pk_bf16_f32 v235, v238, v239
    v_lshlrev_b32 v208, 16, v81
    v_lshlrev_b32 v209, 16, v83
    v_mfma_f32_16x16x32_bf16 v[164:167], v[232:235], v[32:35], v[164:167]
    v_lshlrev_b32 v210, 16, v85
    v_lshlrev_b32 v211, 16, v87
    v_lshlrev_b32 v212, 16, v89
    v_lshlrev_b32 v213, 16, v91
    v_lshlrev_b32 v214, 16, v93
    v_lshlrev_b32 v215, 16, v95
    v_pk_mul_f32 v[208:209], v[208:209], v[184:185]
    v_pk_mul_f32 v[210:211], v[210:211], v[186:187]
    v_pk_mul_f32 v[212:213], v[212:213], v[200:201]
    v_pk_mul_f32 v[214:215], v[214:215], v[202:203]
    v_cvt_pk_bf16_f32 v208, v208, v209
    v_cvt_pk_bf16_f32 v209, v210, v211
    v_cvt_pk_bf16_f32 v210, v212, v213
    v_cvt_pk_bf16_f32 v211, v214, v215
    v_and_b32 v216, v10, v81
    v_and_b32 v217, v10, v83
    v_mfma_f32_16x16x32_bf16 v[168:171], v[208:211], v[32:35], v[168:171]
    v_and_b32 v218, v10, v85
    v_and_b32 v219, v10, v87
    v_and_b32 v220, v10, v89
    v_and_b32 v221, v10, v91
    v_and_b32 v222, v10, v93
    v_and_b32 v223, v10, v95
    v_pk_mul_f32 v[216:217], v[216:217], v[188:189]
    v_pk_mul_f32 v[218:219], v[218:219], v[190:191]
    v_pk_mul_f32 v[220:221], v[220:221], v[204:205]
    v_pk_mul_f32 v[222:223], v[222:223], v[206:207]
    v_cvt_pk_bf16_f32 v216, v216, v217
    v_cvt_pk_bf16_f32 v217, v218, v219
    v_cvt_pk_bf16_f32 v218, v220, v221
    v_cvt_pk_bf16_f32 v219, v222, v223
    s_nop 1
    v_mfma_f32_16x16x32_bf16 v[172:175], v[216:219], v[32:35], v[172:175]
    s_cmp_eq_u32 s73, 0
    s_cbranch_scc1 L2_nopack
    v_cvt_pk_bf16_f32 v176, v112, v116
    v_cvt_pk_bf16_f32 v177, v120, v124
    v_cvt_pk_bf16_f32 v178, v113, v117
    v_cvt_pk_bf16_f32 v179, v121, v125
    v_cvt_pk_bf16_f32 v180, v114, v118
    v_cvt_pk_bf16_f32 v181, v122, v126
    v_cvt_pk_bf16_f32 v182, v115, v119
    v_cvt_pk_bf16_f32 v183, v123, v127
    v_cvt_pk_bf16_f32 v184, v128, v132
    v_cvt_pk_bf16_f32 v185, v136, v140
    v_cvt_pk_bf16_f32 v186, v129, v133
    v_cvt_pk_bf16_f32 v187, v137, v141
    v_cvt_pk_bf16_f32 v188, v130, v134
    v_cvt_pk_bf16_f32 v189, v138, v142
    v_cvt_pk_bf16_f32 v190, v131, v135
    v_cvt_pk_bf16_f32 v191, v139, v143
    v_cvt_pk_bf16_f32 v192, v144, v148
    v_cvt_pk_bf16_f32 v193, v152, v156
    v_cvt_pk_bf16_f32 v194, v145, v149
    v_cvt_pk_bf16_f32 v195, v153, v157
    v_cvt_pk_bf16_f32 v196, v146, v150
    v_cvt_pk_bf16_f32 v197, v154, v158
    v_cvt_pk_bf16_f32 v198, v147, v151
    v_cvt_pk_bf16_f32 v199, v155, v159
    v_cvt_pk_bf16_f32 v200, v160, v164
    v_cvt_pk_bf16_f32 v201, v168, v172
    v_cvt_pk_bf16_f32 v202, v161, v165
    v_cvt_pk_bf16_f32 v203, v169, v173
    v_cvt_pk_bf16_f32 v204, v162, v166
    v_cvt_pk_bf16_f32 v205, v170, v174
    v_cvt_pk_bf16_f32 v206, v163, v167
    v_cvt_pk_bf16_f32 v207, v171, v175
    s_nop 1
    s_branch L2_store
L2_nopack:
    v_mov_b32 v16, 0x40000000
    s_nop 1
L2_store:
    s_mov_b64 exec, s[22:23]
    buffer_store_dwordx4 v[176:179], v16, s[40:43], 0 offen offset:0 sc1 nt
    buffer_store_dwordx4 v[180:183], v16, s[40:43], 0 offen offset:64 sc1 nt
    buffer_store_dwordx4 v[184:187], v16, s[40:43], 0 offen offset:128 sc1 nt
    buffer_store_dwordx4 v[188:191], v16, s[40:43], 0 offen offset:192 sc1 nt
    buffer_store_dwordx4 v[192:195], v16, s[40:43], 0 offen offset:256 sc1 nt
    buffer_store_dwordx4 v[196:199], v16, s[40:43], 0 offen offset:320 sc1 nt
    buffer_store_dwordx4 v[200:203], v16, s[40:43], 0 offen offset:384 sc1 nt
    buffer_store_dwordx4 v[204:207], v16, s[40:43], 0 offen offset:448 sc1 nt
    s_mov_b64 exec, -1
    s_mov_b32 s63, s68
    s_mov_b32 s26, s69
    s_mov_b32 s84, s70
    s_mov_b32 s85, s71
    s_setprio 0
    s_cmp_lg_u32 s72, 0
    s_cbranch_scc1 L2_head_B
    s_sub_u32 s89, s85, s84
    s_cmp_le_u32 s89, 16
    s_cbranch_scc1 L2_head_M
    s_branch L2_head_A
L2_head_M:
    v_and_b32 v208, 127, v17
    v_lshlrev_b32 v209, 4, v208
    ds_read_b128 v[248:251], v209 offset:25600
    ds_write_b16 v3, v208 offset:256
    s_lshl_b32 s89, s63, 9
    v_add_u32 v16, s89, v8
    s_mul_i32 s89, s63, 0x10001
    v_add_u32 v15, s89, v9
    s_bfm_b32 s90, s26, 0
    s_lshl_b32 s91, s90, 16
    s_or_b32 s22, s90, s91
    s_mov_b32 s23, s22
    v_and_b32 v211, 0xff, v15
    v_and_b32 v212, 7, v15
    v_lshlrev_b32 v212, 5, v212
    v_xor_b32 v212, v212, v7
    v_lshl_add_u32 v211, v211, 9, v212
    v_add_u32 v211, 50176, v211
    ds_read_b128 v[176:179], v211
    v_xor_b32 v213, 64, v211
    ds_read_b128 v[180:183], v213
    v_xor_b32 v212, 128, v211
    ds_read_b128 v[184:187], v212
    v_xor_b32 v213, 192, v211
    ds_read_b128 v[188:191], v213
    v_xor_b32 v212, 256, v211
    ds_read_b128 v[192:195], v212
    v_xor_b32 v213, 320, v211
    ds_read_b128 v[196:199], v213
    v_xor_b32 v212, 384, v211
    ds_read_b128 v[200:203], v212
    v_xor_b32 v213, 448, v211
    ds_read_b128 v[204:207], v213
    v_ashrrev_i32 v19, 31, v17
    s_waitcnt vmcnt(12)
    v_alignbyte_b32 v20, v21, v20, v253
    v_alignbyte_b32 v21, v21, v21, v253
    v_lshlrev_b32 v208, 16, v20
    v_and_b32 v209, v10, v20
    v_lshlrev_b32 v210, 16, v21
    s_waitcnt lgkmcnt(9)
    v_sub_f32 v208, v208, v248
    v_sub_f32 v209, v209, v249
    v_sub_f32 v210, v210, v250
    v_cvt_pk_bf16_f32 v208, 0, v208
    v_cvt_pk_bf16_f32 v209, 0, v209
    v_cvt_pk_bf16_f32 v210, 0, v210
    v_mul_f32 v211, v208, v208
    v_mul_f32 v212, v209, v209
    v_mul_f32 v213, v210, v210
    s_waitcnt lgkmcnt(0)
    v_cvt_pk_bf16_f32 v211, 0, v211
    v_lshlrev_b32 v112, 16, v176
    v_cvt_pk_bf16_f32 v212, 0, v212
    v_lshlrev_b32 v113, 16, v178
    v_cvt_pk_bf16_f32 v213, 0, v213
    v_and_b32 v116, v10, v176
    v_add_f32 v211, v211, v212
    v_and_b32 v117, v10, v178
    v_add_f32 v211, v211, v213
    v_lshlrev_b32 v120, 16, v177
    v_cvt_pk_bf16_f32 v211, 0, v211
    v_lshlrev_b32 v121, 16, v179
    v_add_f32 v211, 0x322bcc77, v211
    v_and_b32 v124, v10, v177
    v_cvt_pk_bf16_f32 v211, 0, v211
    v_and_b32 v125, v10, v179
    v_sqrt_f32 v211, v211
    v_lshlrev_b32 v114, 16, v180
    v_cvt_pk_bf16_f32 v214, 0, v211
    v_lshlrev_b32 v115, 16, v182
    v_rcp_f32 v215, v214
    v_and_b32 v118, v10, v180
    v_mul_f32 v220, 0x40490fdb, v214
    v_and_b32 v119, v10, v182
    v_mul_f32 v216, s56, v214
    v_lshlrev_b32 v122, 16, v181
    v_mul_f32 v217, s57, v214
    v_lshlrev_b32 v123, 16, v183
    v_mul_f32 v218, s58, v214
    v_and_b32 v126, v10, v181
    v_and_b32 v127, v10, v183
    v_mul_f32 v219, s59, v214
    v_lshlrev_b32 v128, 16, v184
    v_cvt_pk_bf16_f32 v220, 0, v220
    v_lshlrev_b32 v129, 16, v186
    v_mul_f32 v220, 0x3e4ccccd, v220
    v_and_b32 v132, v10, v184
    v_cvt_pk_bf16_f32 v216, 0, v216
    v_and_b32 v133, v10, v186
    v_cvt_pk_bf16_f32 v217, 0, v217
    v_lshlrev_b32 v136, 16, v185
    v_cvt_pk_bf16_f32 v220, 0, v220
    v_lshlrev_b32 v137, 16, v187
    v_cvt_pk_bf16_f32 v218, 0, v218
    v_and_b32 v140, v10, v185
    v_cvt_pk_bf16_f32 v219, 0, v219
    v_and_b32 v141, v10, v187
    v_mul_f32 v220, 0.15915494, v220
    v_lshlrev_b32 v130, 16, v188
    v_mul_f32 v208, v208, v215
    v_lshlrev_b32 v131, 16, v190
    v_mul_f32 v209, v209, v215
    v_and_b32 v134, v10, v188
    v_mul_f32 v210, v210, v215
    v_and_b32 v135, v10, v190
    v_cos_f32 v220, v220
    v_lshlrev_b32 v138, 16, v189
    v_mul_f32 v216, 0.15915494, v216
    v_lshlrev_b32 v139, 16, v191
    v_mul_f32 v217, 0.15915494, v217
    v_and_b32 v142, v10, v189
    v_and_b32 v143, v10, v191
    v_mul_f32 v218, 0.15915494, v218
    v_lshlrev_b32 v144, 16, v192
    v_mul_f32 v219, 0.15915494, v219
    v_lshlrev_b32 v145, 16, v194
    v_cvt_pk_bf16_f32 v211, v208, v209
    v_and_b32 v148, v10, v192
    v_cvt_pk_bf16_f32 v212, v210, v210
    v_and_b32 v149, v10, v194
    v_cvt_pk_bf16_f32 v220, 0, v220
    v_lshlrev_b32 v152, 16, v193
    v_sin_f32 v216, v216
    v_lshlrev_b32 v153, 16, v195
    v_sin_f32 v217, v217
    v_and_b32 v156, v10, v193
    v_bitop3_b32 v211, v211, v19, v19 bitop3:0x30
    v_and_b32 v157, v10, v195
    v_bitop3_b32 v212, v212, v19, v19 bitop3:0x30
    v_lshlrev_b32 v146, 16, v196
    v_add_f32 v220, 1.0, v220
    v_lshlrev_b32 v147, 16, v198
    ds_write_b16 v3, v211 offset:384
    v_and_b32 v150, v10, v196
    ds_write_b16_d16_hi v3, v211 offset:512
    v_and_b32 v151, v10, v198
    ds_write_b16 v3, v212 offset:640
    v_lshlrev_b32 v154, 16, v197
    ds_read_b64 v[32:33], v5 offset:256
    v_lshlrev_b32 v155, 16, v199
    ds_read_b64 v[36:37], v5 offset:384
    v_and_b32 v158, v10, v197
    v_and_b32 v159, v10, v199
    ds_read_b64 v[40:41], v5 offset:512
    v_lshlrev_b32 v160, 16, v200
    ds_read_b64 v[44:45], v5 offset:640
    v_lshlrev_b32 v161, 16, v202
    v_sin_f32 v218, v218
    v_and_b32 v164, v10, v200
    v_sin_f32 v219, v219
    v_and_b32 v165, v10, v202
    v_cvt_pk_bf16_f32 v220, 0, v220
    v_lshlrev_b32 v168, 16, v201
    v_mul_f32 v215, 0.5, v215
    v_lshlrev_b32 v169, 16, v203
    v_mul_f32 v215, v215, v220
    v_and_b32 v172, v10, v201
    v_mul_f32 v216, v216, v215
    v_and_b32 v173, v10, v203
    v_mul_f32 v217, v217, v215
    v_lshlrev_b32 v162, 16, v204
    v_mul_f32 v218, v218, v215
    v_lshlrev_b32 v163, 16, v206
    v_mul_f32 v219, v219, v215
    v_and_b32 v166, v10, v204
    v_cvt_pk_bf16_f32 v22, v216, v217
    v_and_b32 v167, v10, v206
    v_cvt_pk_bf16_f32 v23, v218, v219
    v_lshlrev_b32 v170, 16, v205
    v_bitop3_b32 v22, v22, v19, v19 bitop3:0x30
    v_lshlrev_b32 v171, 16, v207
    v_bitop3_b32 v23, v23, v19, v19 bitop3:0x30
    v_and_b32 v174, v10, v205
    v_and_b32 v175, v10, v207
    ds_read_b128 v[224:227], v1 offset:0
    ds_read_b128 v[228:231], v1 offset:1024
    ds_read_b128 v[232:235], v1 offset:2048
    ds_read_b128 v[236:239], v1 offset:3072
    s_mov_b32 s89, 0x00010001
    s_waitcnt lgkmcnt(7)
    v_xor_b32 v32, v32, v15
    v_xor_b32 v33, v33, v15
    v_mfma_f32_16x16x4bf16_1k v[176:191], v[22:23], v[24:25], 0 cbsz:2 abid:0
    v_pk_min_u16 v32, v32, s89
    v_pk_min_u16 v33, v33, s89
    v_pk_sub_u16 v32, v32, s89
    v_pk_sub_u16 v33, v33, s89
    s_waitcnt lgkmcnt(4)
    v_and_b32 v36, v36, v32
    v_and_b32 v37, v37, v33
    v_and_b32 v40, v40, v32
    v_and_b32 v41, v41, v33
    v_and_b32 v44, v44, v32
    v_and_b32 v45, v45, v33
    v_and_b32 v32, 0x3f803f80, v32
    v_and_b32 v33, 0x3f803f80, v33
    buffer_load_dwordx2 v[48:49], v240, s[28:31], 0 offen offset:128
    buffer_load_dwordx2 v[50:51], v241, s[28:31], 0 offen offset:128
    buffer_load_dwordx2 v[52:53], v242, s[28:31], 0 offen offset:128
    buffer_load_dwordx2 v[54:55], v243, s[28:31], 0 offen offset:128
    s_waitcnt vmcnt(12)
    s_waitcnt lgkmcnt(2)
    v_mfma_f32_16x16x32_bf16 v[208:211], v[96:99], v[224:227], 0
    v_mfma_f32_16x16x32_bf16 v[208:211], v[100:103], v[228:231], v[208:211]
    ds_read_b128 v[224:227], v1 offset:4096
    ds_read_b128 v[228:231], v1 offset:5120
    s_waitcnt lgkmcnt(2)
    v_mfma_f32_16x16x32_bf16 v[216:219], v[96:99], v[232:235], 0
    v_mfma_f32_16x16x32_bf16 v[216:219], v[100:103], v[236:239], v[216:219]
    s_nop 2
    v_mul_f32 v208, v208, v176
    v_mul_f32 v209, v209, v177
    v_mul_f32 v210, v210, v178
    v_mul_f32 v211, v211, v179
    v_cvt_pk_bf16_f32 v208, v208, v209
    v_cvt_pk_bf16_f32 v209, v210, v211
    ds_read_b128 v[232:235], v1 offset:6144
    ds_read_b128 v[236:239], v1 offset:7168
    v_mfma_f32_16x16x16bf16_1k v[112:115], v[208:209], v[32:33], v[112:115]
    s_waitcnt lgkmcnt(2)
    v_mfma_f32_16x16x32_bf16 v[208:211], v[96:99], v[224:227], 0
    v_mfma_f32_16x16x32_bf16 v[208:211], v[100:103], v[228:231], v[208:211]
    v_mul_f32 v216, v216, v180
    v_mul_f32 v217, v217, v181
    v_mul_f32 v218, v218, v182
    v_mul_f32 v219, v219, v183
    v_cvt_pk_bf16_f32 v216, v216, v217
    v_cvt_pk_bf16_f32 v217, v218, v219
    ds_read_b128 v[224:227], v1 offset:16384
    ds_read_b128 v[228:231], v1 offset:17408
    v_mfma_f32_16x16x16bf16_1k v[116:119], v[216:217], v[32:33], v[116:119]
    s_waitcnt lgkmcnt(2)
    v_mfma_f32_16x16x32_bf16 v[216:219], v[96:99], v[232:235], 0
    v_mfma_f32_16x16x32_bf16 v[216:219], v[100:103], v[236:239], v[216:219]
    v_mul_f32 v208, v208, v184
    v_mul_f32 v209, v209, v185
    v_mul_f32 v210, v210, v186
    v_mul_f32 v211, v211, v187
    v_cvt_pk_bf16_f32 v208, v208, v209
    v_cvt_pk_bf16_f32 v209, v210, v211
    ds_read_b128 v[232:235], v1 offset:18432
    ds_read_b128 v[236:239], v1 offset:19456
    v_mfma_f32_16x16x16bf16_1k v[120:123], v[208:209], v[32:33], v[120:123]
    buffer_load_dwordx2 v[64:65], v240, s[28:31], 0 offen offset:256
    buffer_load_dwordx2 v[66:67], v241, s[28:31], 0 offen offset:256
    buffer_load_dwordx2 v[68:69], v242, s[28:31], 0 offen offset:256
    buffer_load_dwordx2 v[70:71], v243, s[28:31], 0 offen offset:256
    s_waitcnt lgkmcnt(2)
    v_mfma_f32_16x16x32_bf16 v[208:211], v[96:99], v[224:227], 0
    v_mfma_f32_16x16x32_bf16 v[208:211], v[100:103], v[228:231], v[208:211]
    v_mul_f32 v216, v216, v188
    v_mul_f32 v217, v217, v189
    v_mul_f32 v218, v218, v190
    v_mul_f32 v219, v219, v191
    v_mfma_f32_16x16x4bf16_1k v[176:191], v[22:23], v[28:29], 0 cbsz:2 abid:0
    v_cvt_pk_bf16_f32 v216, v216, v217
    v_cvt_pk_bf16_f32 v217, v218, v219
    ds_read_b128 v[224:227], v1 offset:20480
    ds_read_b128 v[228:231], v1 offset:21504
    v_mfma_f32_16x16x16bf16_1k v[124:127], v[216:217], v[32:33], v[124:127]
    s_waitcnt lgkmcnt(2)
    v_mfma_f32_16x16x32_bf16 v[216:219], v[96:99], v[232:235], 0
    v_mfma_f32_16x16x32_bf16 v[216:219], v[100:103], v[236:239], v[216:219]
    s_nop 3
    v_mul_f32 v208, v208, v176
    v_mul_f32 v209, v209, v177
    v_mul_f32 v210, v210, v178
    v_mul_f32 v211, v211, v179
    v_cvt_pk_bf16_f32 v208, v208, v209
    v_cvt_pk_bf16_f32 v209, v210, v211
    ds_read_b128 v[232:235], v1 offset:22528
    ds_read_b128 v[236:239], v1 offset:23552
    v_mfma_f32_16x16x16bf16_1k v[128:131], v[208:209], v[36:37], v[128:131]
    v_mfma_f32_16x16x16bf16_1k v[144:147], v[208:209], v[40:41], v[144:147]
    v_mfma_f32_16x16x16bf16_1k v[160:163], v[208:209], v[44:45], v[160:163]
    s_waitcnt lgkmcnt(2)
    v_mfma_f32_16x16x32_bf16 v[208:211], v[96:99], v[224:227], 0
    v_mfma_f32_16x16x32_bf16 v[208:211], v[100:103], v[228:231], v[208:211]
    v_mul_f32 v216, v216, v180
    v_mul_f32 v217, v217, v181
    v_mul_f32 v218, v218, v182
    v_mul_f32 v219, v219, v183
    v_cvt_pk_bf16_f32 v216, v216, v217
    v_cvt_pk_bf16_f32 v217, v218, v219
    ds_read_b128 v[224:227], v1 offset:8192
    ds_read_b128 v[228:231], v1 offset:9216
    v_mfma_f32_16x16x16bf16_1k v[132:135], v[216:217], v[36:37], v[132:135]
    v_mfma_f32_16x16x16bf16_1k v[148:151], v[216:217], v[40:41], v[148:151]
    v_mfma_f32_16x16x16bf16_1k v[164:167], v[216:217], v[44:45], v[164:167]
    s_waitcnt lgkmcnt(2)
    v_mfma_f32_16x16x32_bf16 v[216:219], v[96:99], v[232:235], 0
    v_mfma_f32_16x16x32_bf16 v[216:219], v[100:103], v[236:239], v[216:219]
    v_mul_f32 v208, v208, v184
    v_mul_f32 v209, v209, v185
    v_mul_f32 v210, v210, v186
    v_mul_f32 v211, v211, v187
    v_cvt_pk_bf16_f32 v208, v208, v209
    v_cvt_pk_bf16_f32 v209, v210, v211
    ds_read_b128 v[232:235], v1 offset:10240
    ds_read_b128 v[236:239], v1 offset:11264
    v_mfma_f32_16x16x16bf16_1k v[136:139], v[208:209], v[36:37], v[136:139]
    v_mfma_f32_16x16x16bf16_1k v[152:155], v[208:209], v[40:41], v[152:155]
    v_mfma_f32_16x16x16bf16_1k v[168:171], v[208:209], v[44:45], v[168:171]
    buffer_load_dwordx2 v[80:81], v240, s[28:31], 0 offen offset:384
    buffer_load_dwordx2 v[82:83], v241, s[28:31], 0 offen offset:384
    buffer_load_dwordx2 v[84:85], v242, s[28:31], 0 offen offset:384
    buffer_load_dwordx2 v[86:87], v243, s[28:31], 0 offen offset:384
    s_waitcnt lgkmcnt(2)
    v_mfma_f32_16x16x32_bf16 v[208:211], v[96:99], v[224:227], 0
    v_mfma_f32_16x16x32_bf16 v[208:211], v[100:103], v[228:231], v[208:211]
    v_mul_f32 v216, v216, v188
    v_mul_f32 v217, v217, v189
    v_mul_f32 v218, v218, v190
    v_mul_f32 v219, v219, v191
    v_mfma_f32_16x16x4bf16_1k v[176:191], v[22:23], v[26:27], 0 cbsz:2 abid:0
    v_cvt_pk_bf16_f32 v216, v216, v217
    v_cvt_pk_bf16_f32 v217, v218, v219
    ds_read_b128 v[224:227], v1 offset:12288
    ds_read_b128 v[228:231], v1 offset:13312
    v_mfma_f32_16x16x16bf16_1k v[140:143], v[216:217], v[36:37], v[140:143]
    v_mfma_f32_16x16x16bf16_1k v[156:159], v[216:217], v[40:41], v[156:159]
    v_mfma_f32_16x16x16bf16_1k v[172:175], v[216:217], v[44:45], v[172:175]
    s_waitcnt lgkmcnt(2)
    v_mfma_f32_16x16x32_bf16 v[216:219], v[96:99], v[232:235], 0
    v_mfma_f32_16x16x32_bf16 v[216:219], v[100:103], v[236:239], v[216:219]
    s_nop 1
    v_mul_f32 v176, v208, v176
    v_mul_f32 v177, v209, v177
    v_mul_f32 v178, v210, v178
    v_mul_f32 v179, v211, v179
    ds_read_b128 v[232:235], v1 offset:14336
    ds_read_b128 v[236:239], v1 offset:15360
    s_waitcnt lgkmcnt(2)
    v_mfma_f32_16x16x32_bf16 v[208:211], v[96:99], v[224:227], 0
    v_mfma_f32_16x16x32_bf16 v[208:211], v[100:103], v[228:231], v[208:211]
    v_mul_f32 v180, v216, v180
    v_mul_f32 v181, v217, v181
    v_mul_f32 v182, v218, v182
    v_mul_f32 v183, v219, v183
    s_waitcnt lgkmcnt(0)
    v_mfma_f32_16x16x32_bf16 v[216:219], v[96:99], v[232:235], 0
    v_mfma_f32_16x16x32_bf16 v[216:219], v[100:103], v[236:239], v[216:219]
    s_nop 0
    v_mul_f32 v184, v208, v184
    v_mul_f32 v185, v209, v185
    v_mul_f32 v186, v210, v186
    v_mul_f32 v187, v211, v187
    s_nop 2
    s_setprio 1
    v_mul_f32 v188, v216, v188
    v_mul_f32 v189, v217, v189
    v_mul_f32 v190, v218, v190
    v_mul_f32 v191, v219, v191
    s_waitcnt vmcnt(8)
    v_lshlrev_b32 v224, 16, v48
    v_lshlrev_b32 v225, 16, v50
    v_lshlrev_b32 v226, 16, v52
    v_lshlrev_b32 v227, 16, v54
    v_pk_mul_f32 v[224:225], v[224:225], v[176:177]
    v_pk_mul_f32 v[226:227], v[226:227], v[178:179]
    v_cvt_pk_bf16_f32 v224, v224, v225
    v_cvt_pk_bf16_f32 v225, v226, v227
    v_and_b32 v232, v10, v48
    v_and_b32 v233, v10, v50
    v_mfma_f32_16x16x16bf16_1k v[128:131], v[224:225], v[32:33], v[128:131]
    v_and_b32 v234, v10, v52
    v_and_b32 v235, v10, v54
    v_pk_mul_f32 v[232:233], v[232:233], v[180:181]
    v_pk_mul_f32 v[234:235], v[234:235], v[182:183]
    v_cvt_pk_bf16_f32 v232, v232, v233
    v_cvt_pk_bf16_f32 v233, v234, v235
    v_lshlrev_b32 v208, 16, v49
    v_lshlrev_b32 v209, 16, v51
    v_mfma_f32_16x16x16bf16_1k v[132:135], v[232:233], v[32:33], v[132:135]
    v_lshlrev_b32 v210, 16, v53
    v_lshlrev_b32 v211, 16, v55
    v_pk_mul_f32 v[208:209], v[208:209], v[184:185]
    v_pk_mul_f32 v[210:211], v[210:211], v[186:187]
    v_cvt_pk_bf16_f32 v208, v208, v209
    v_cvt_pk_bf16_f32 v209, v210, v211
    v_and_b32 v216, v10, v49
    v_and_b32 v217, v10, v51
    v_mfma_f32_16x16x16bf16_1k v[136:139], v[208:209], v[32:33], v[136:139]
    v_and_b32 v218, v10, v53
    v_and_b32 v219, v10, v55
    v_pk_mul_f32 v[216:217], v[216:217], v[188:189]
    v_pk_mul_f32 v[218:219], v[218:219], v[190:191]
    v_cvt_pk_bf16_f32 v216, v216, v217
    v_cvt_pk_bf16_f32 v217, v218, v219
    s_waitcnt vmcnt(4)
    v_lshlrev_b32 v224, 16, v64
    v_lshlrev_b32 v225, 16, v66
    v_mfma_f32_16x16x16bf16_1k v[140:143], v[216:217], v[32:33], v[140:143]
    v_lshlrev_b32 v226, 16, v68
    v_lshlrev_b32 v227, 16, v70
    v_pk_mul_f32 v[224:225], v[224:225], v[176:177]
    v_pk_mul_f32 v[226:227], v[226:227], v[178:179]
    v_cvt_pk_bf16_f32 v224, v224, v225
    v_cvt_pk_bf16_f32 v225, v226, v227
    v_and_b32 v232, v10, v64
    v_and_b32 v233, v10, v66
    v_mfma_f32_16x16x16bf16_1k v[144:147], v[224:225], v[32:33], v[144:147]
    v_and_b32 v234, v10, v68
    v_and_b32 v235, v10, v70
    v_pk_mul_f32 v[232:233], v[232:233], v[180:181]
    v_pk_mul_f32 v[234:235], v[234:235], v[182:183]
    v_cvt_pk_bf16_f32 v232, v232, v233
    v_cvt_pk_bf16_f32 v233, v234, v235
    v_cvt_pk_bf16_f32 v48, v112, v116
    v_cvt_pk_bf16_f32 v49, v120, v124
    v_cvt_pk_bf16_f32 v50, v113, v117
    v_cvt_pk_bf16_f32 v51, v121, v125
    v_cvt_pk_bf16_f32 v52, v114, v118
    v_cvt_pk_bf16_f32 v53, v122, v126
    v_cvt_pk_bf16_f32 v54, v115, v119
    v_cvt_pk_bf16_f32 v55, v123, v127
    v_cvt_pk_bf16_f32 v56, v128, v132
    v_cvt_pk_bf16_f32 v57, v136, v140
    v_cvt_pk_bf16_f32 v58, v129, v133
    v_cvt_pk_bf16_f32 v59, v137, v141
    v_cvt_pk_bf16_f32 v60, v130, v134
    v_cvt_pk_bf16_f32 v61, v138, v142
    v_cvt_pk_bf16_f32 v62, v131, v135
    v_cvt_pk_bf16_f32 v63, v139, v143
    s_mov_b64 exec, s[22:23]
    buffer_store_dwordx4 v[48:51], v16, s[40:43], 0 offen offset:0 sc1 nt
    buffer_store_dwordx4 v[52:55], v16, s[40:43], 0 offen offset:64 sc1 nt
    buffer_store_dwordx4 v[56:59], v16, s[40:43], 0 offen offset:128 sc1 nt
    buffer_store_dwordx4 v[60:63], v16, s[40:43], 0 offen offset:192 sc1 nt
    s_mov_b64 exec, -1
    v_lshlrev_b32 v208, 16, v65
    v_lshlrev_b32 v209, 16, v67
    v_mfma_f32_16x16x16bf16_1k v[148:151], v[232:233], v[32:33], v[148:151]
    v_lshlrev_b32 v210, 16, v69
    v_lshlrev_b32 v211, 16, v71
    v_pk_mul_f32 v[208:209], v[208:209], v[184:185]
    v_pk_mul_f32 v[210:211], v[210:211], v[186:187]
    v_cvt_pk_bf16_f32 v208, v208, v209
    v_cvt_pk_bf16_f32 v209, v210, v211
    v_and_b32 v216, v10, v65
    v_and_b32 v217, v10, v67
    v_mfma_f32_16x16x16bf16_1k v[152:155], v[208:209], v[32:33], v[152:155]
    v_and_b32 v218, v10, v69
    v_and_b32 v219, v10, v71
    v_pk_mul_f32 v[216:217], v[216:217], v[188:189]
    v_pk_mul_f32 v[218:219], v[218:219], v[190:191]
    v_cvt_pk_bf16_f32 v216, v216, v217
    v_cvt_pk_bf16_f32 v217, v218, v219
    s_waitcnt vmcnt(4)
    v_lshlrev_b32 v224, 16, v80
    v_lshlrev_b32 v225, 16, v82
    v_mfma_f32_16x16x16bf16_1k v[156:159], v[216:217], v[32:33], v[156:159]
    v_lshlrev_b32 v226, 16, v84
    v_lshlrev_b32 v227, 16, v86
    v_pk_mul_f32 v[224:225], v[224:225], v[176:177]
    v_pk_mul_f32 v[226:227], v[226:227], v[178:179]
    v_cvt_pk_bf16_f32 v224, v224, v225
    v_cvt_pk_bf16_f32 v225, v226, v227
    v_and_b32 v232, v10, v80
    v_and_b32 v233, v10, v82
    v_mfma_f32_16x16x16bf16_1k v[160:163], v[224:225], v[32:33], v[160:163]
    v_and_b32 v234, v10, v84
    v_and_b32 v235, v10, v86
    v_pk_mul_f32 v[232:233], v[232:233], v[180:181]
    v_pk_mul_f32 v[234:235], v[234:235], v[182:183]
    v_cvt_pk_bf16_f32 v232, v232, v233
    v_cvt_pk_bf16_f32 v233, v234, v235
    v_cvt_pk_bf16_f32 v64, v144, v148
    v_cvt_pk_bf16_f32 v65, v152, v156
    v_cvt_pk_bf16_f32 v66, v145, v149
    v_cvt_pk_bf16_f32 v67, v153, v157
    v_cvt_pk_bf16_f32 v68, v146, v150
    v_cvt_pk_bf16_f32 v69, v154, v158
    v_cvt_pk_bf16_f32 v70, v147, v151
    v_cvt_pk_bf16_f32 v71, v155, v159
    s_mov_b64 exec, s[22:23]
    buffer_store_dwordx4 v[64:67], v16, s[40:43], 0 offen offset:256 sc1 nt
    buffer_store_dwordx4 v[68:71], v16, s[40:43], 0 offen offset:320 sc1 nt
    s_mov_b64 exec, -1
    v_lshlrev_b32 v208, 16, v81
    v_lshlrev_b32 v209, 16, v83
    v_mfma_f32_16x16x16bf16_1k v[164:167], v[232:233], v[32:33], v[164:167]
    v_lshlrev_b32 v210, 16, v85
    v_lshlrev_b32 v211, 16, v87
    v_pk_mul_f32 v[208:209], v[208:209], v[184:185]
    v_pk_mul_f32 v[210:211], v[210:211], v[186:187]
    v_cvt_pk_bf16_f32 v208, v208, v209
    v_cvt_pk_bf16_f32 v209, v210, v211
    v_and_b32 v216, v10, v81
    v_and_b32 v217, v10, v83
    v_mfma_f32_16x16x16bf16_1k v[168:171], v[208:209], v[32:33], v[168:171]
    v_and_b32 v218, v10, v85
    v_and_b32 v219, v10, v87
    v_pk_mul_f32 v[216:217], v[216:217], v[188:189]
    v_pk_mul_f32 v[218:219], v[218:219], v[190:191]
    v_cvt_pk_bf16_f32 v216, v216, v217
    v_cvt_pk_bf16_f32 v217, v218, v219
    s_nop 1
    v_mfma_f32_16x16x16bf16_1k v[172:175], v[216:217], v[32:33], v[172:175]
    v_cvt_pk_bf16_f32 v200, v160, v164
    s_nop 6
    v_cvt_pk_bf16_f32 v201, v168, v172
    v_cvt_pk_bf16_f32 v202, v161, v165
    v_cvt_pk_bf16_f32 v203, v169, v173
    v_cvt_pk_bf16_f32 v204, v162, v166
    v_cvt_pk_bf16_f32 v205, v170, v174
    v_cvt_pk_bf16_f32 v206, v163, v167
    v_cvt_pk_bf16_f32 v207, v171, v175
    s_mov_b64 exec, s[22:23]
    buffer_store_dwordx4 v[200:203], v16, s[40:43], 0 offen offset:384 sc1 nt
    buffer_store_dwordx4 v[204:207], v16, s[40:43], 0 offen offset:448 sc1 nt
    s_mov_b64 exec, -1
    s_cmp_eq_u32 s61, 0
    s_cbranch_scc1 L2_walkdone5
L2_walk5:
    v_readlane_b32 s89, v13, s60
    s_lshr_b32 s90, s60, 2
    s_and_b32 s90, s90, 16
    s_lshr_b32 s89, s89, s90
    s_and_b32 s60, s89, 0xffff
    s_sub_u32 s61, s61, 1
    s_cmp_lg_u32 s61, 0
    s_cbranch_scc1 L2_walk5
L2_walkdone5:
    s_cmp_eq_u32 s62, 0
    s_cbranch_scc1 L2_walkdone6
L2_walk6:
    v_readlane_b32 s89, v18, s60
    s_lshr_b32 s90, s60, 2
    s_and_b32 s90, s90, 16
    s_lshr_b32 s89, s89, s90
    s_and_b32 s60, s89, 0xffff
    s_sub_u32 s62, s62, 1
    s_cmp_lg_u32 s62, 0
    s_cbranch_scc1 L2_walk6
L2_walkdone6:
    s_cmp_ge_u32 s60, 100
    s_cbranch_scc1 L2_rounddone
    s_cmp_eq_u32 s76, 0
    s_cbranch_scc1 L2_nomode1
    v_readlane_b32 s89, v12, s60
    s_lshr_b32 s90, s60, 2
    s_and_b32 s90, s90, 16
    s_lshr_b32 s89, s89, s90
    s_and_b32 s91, s89, 0xffff
    s_sub_u32 s91, s79, s91
    s_cmp_gt_u32 s91, 54
    s_cbranch_scc0 L2_small1
    v_mov_b32 v13, v18
    s_nop 1
    s_branch L2_nomode1
L2_small1:
    v_and_b32 v248, 0xffff, v12
    v_lshrrev_b32 v249, 16, v12
    v_add_u32 v248, 16, v248
    v_add_u32 v249, 16, v249
    v_lshlrev_b32 v250, 2, v248
    v_lshlrev_b32 v251, 2, v249
    ds_read_b32 v250, v250 offset:33824
    ds_read_b32 v251, v251 offset:33824
    v_cmp_gt_u32 s[64:65], s79, v248
    v_cmp_gt_u32 s[66:67], s79, v249
    v_mov_b32 v254, 100
    v_lshrrev_b32 v255, 4, v1
    s_waitcnt lgkmcnt(0)
    v_and_b32 v250, 127, v250
    v_cndmask_b32_e64 v250, v254, v250, s[64:65]
    v_add_u32 v248, 1, v255
    v_add_u32 v249, 16, v255
    v_med3_u32 v250, v250, v248, v249
    v_min_u32 v250, v254, v250
    v_and_b32 v251, 127, v251
    v_cndmask_b32_e64 v251, v254, v251, s[66:67]
    v_add_u32 v248, 65, v255
    v_add_u32 v249, 80, v255
    v_med3_u32 v251, v251, v248, v249
    v_min_u32 v251, v254, v251
    v_lshl_or_b32 v13, v251, 16, v250
    s_nop 1
L2_nomode1:
    s_cmp_eq_u32 s74, 0
    s_cbranch_scc1 L2_walkdone7
L2_walk7:
    v_readlane_b32 s89, v13, s60
    s_lshr_b32 s90, s60, 2
    s_and_b32 s90, s90, 16
    s_lshr_b32 s89, s89, s90
    s_and_b32 s60, s89, 0xffff
    s_sub_u32 s74, s74, 1
    s_cmp_lg_u32 s74, 0
    s_cbranch_scc1 L2_walk7
L2_walkdone7:
    s_cmp_eq_u32 s75, 0
    s_cbranch_scc1 L2_walkdone8
L2_walk8:
    v_readlane_b32 s89, v18, s60
    s_lshr_b32 s90, s60, 2
    s_and_b32 s90, s90, 16
    s_lshr_b32 s89, s89, s90
    s_and_b32 s60, s89, 0xffff
    s_sub_u32 s75, s75, 1
    s_cmp_lg_u32 s75, 0
    s_cbranch_scc1 L2_walk8
L2_walkdone8:
    s_cmp_ge_u32 s60, 100
    s_cbranch_scc1 L2_rounddone
    s_mov_b32 s63, s60
    v_readlane_b32 s89, v12, s60
    s_lshr_b32 s90, s60, 2
    s_and_b32 s90, s90, 16
    s_lshr_b32 s89, s89, s90
    s_and_b32 s84, s89, 0xffff
    s_cmp_eq_u32 s77, 0
    s_cbranch_scc1 L2_end32_1
    v_readlane_b32 s89, v13, s60
    s_lshr_b32 s90, s60, 2
    s_and_b32 s90, s90, 16
    s_lshr_b32 s89, s89, s90
    s_and_b32 s60, s89, 0xffff
    s_branch L2_ended1
L2_end32_1:
    v_readlane_b32 s89, v18, s60
    s_lshr_b32 s90, s60, 2
    s_and_b32 s90, s90, 16
    s_lshr_b32 s89, s89, s90
    s_and_b32 s60, s89, 0xffff
L2_ended1:
    v_readlane_b32 s89, v12, s60
    s_lshr_b32 s90, s60, 2
    s_and_b32 s90, s90, 16
    s_lshr_b32 s89, s89, s90
    s_and_b32 s85, s89, 0xffff
    s_mov_b32 s77, 0
    s_cmp_lg_u32 s78, 0
    s_cbranch_scc1 L2_later1
    s_mov_b32 s78, 1
    s_mov_b32 s75, s3
    s_xor_b32 s76, s76, 1
    s_sub_u32 s89, 3, s3
    s_max_i32 s62, s89, 0
    s_sub_u32 s89, 7, s3
    s_min_u32 s74, s89, 4
    s_branch L2_walked1
L2_later1:
    s_mov_b32 s62, 7
    s_mov_b32 s76, 0
L2_walked1:
    s_branch L2_issue
L2_tail_fin:
    s_setprio 1
    v_mul_f32 v188, v216, v188
    v_mul_f32 v189, v217, v189
    v_mul_f32 v190, v218, v190
    v_mul_f32 v191, v219, v191
    v_mul_f32 v204, v220, v204
    v_mul_f32 v205, v221, v205
    v_mul_f32 v206, v222, v206
    v_mul_f32 v207, v223, v207
    s_waitcnt vmcnt(16)
    v_lshlrev_b32 v224, 16, v48
    v_lshlrev_b32 v225, 16, v50
    v_lshlrev_b32 v226, 16, v52
    v_lshlrev_b32 v227, 16, v54
    v_lshlrev_b32 v228, 16, v56
    v_lshlrev_b32 v229, 16, v58
    v_lshlrev_b32 v230, 16, v60
    v_lshlrev_b32 v231, 16, v62
    v_pk_mul_f32 v[224:225], v[224:225], v[176:177]
    v_pk_mul_f32 v[226:227], v[226:227], v[178:179]
    v_pk_mul_f32 v[228:229], v[228:229], v[192:193]
    v_pk_mul_f32 v[230:231], v[230:231], v[194:195]
    v_cvt_pk_bf16_f32 v224, v224, v225
    v_cvt_pk_bf16_f32 v225, v226, v227
    v_cvt_pk_bf16_f32 v226, v228, v229
    v_cvt_pk_bf16_f32 v227, v230, v231
    v_and_b32 v232, v10, v48
    v_and_b32 v233, v10, v50
    v_mfma_f32_16x16x32_bf16 v[128:131], v[224:227], v[32:35], v[128:131]
    v_and_b32 v234, v10, v52
    v_and_b32 v235, v10, v54
    v_and_b32 v236, v10, v56
    v_and_b32 v237, v10, v58
    v_and_b32 v238, v10, v60
    v_and_b32 v239, v10, v62
    v_pk_mul_f32 v[232:233], v[232:233], v[180:181]
    v_pk_mul_f32 v[234:235], v[234:235], v[182:183]
    v_pk_mul_f32 v[236:237], v[236:237], v[196:197]
    v_pk_mul_f32 v[238:239], v[238:239], v[198:199]
    v_cvt_pk_bf16_f32 v232, v232, v233
    v_cvt_pk_bf16_f32 v233, v234, v235
    v_cvt_pk_bf16_f32 v234, v236, v237
    v_cvt_pk_bf16_f32 v235, v238, v239
    v_lshlrev_b32 v208, 16, v49
    v_lshlrev_b32 v209, 16, v51
    v_mfma_f32_16x16x32_bf16 v[132:135], v[232:235], v[32:35], v[132:135]
    v_lshlrev_b32 v210, 16, v53
    v_lshlrev_b32 v211, 16, v55
    v_lshlrev_b32 v212, 16, v57
    v_lshlrev_b32 v213, 16, v59
    v_lshlrev_b32 v214, 16, v61
    v_lshlrev_b32 v215, 16, v63
    v_pk_mul_f32 v[208:209], v[208:209], v[184:185]
    v_pk_mul_f32 v[210:211], v[210:211], v[186:187]
    v_pk_mul_f32 v[212:213], v[212:213], v[200:201]
    v_pk_mul_f32 v[214:215], v[214:215], v[202:203]
    v_cvt_pk_bf16_f32 v208, v208, v209
    v_cvt_pk_bf16_f32 v209, v210, v211
    v_cvt_pk_bf16_f32 v210, v212, v213
    v_cvt_pk_bf16_f32 v211, v214, v215
    v_and_b32 v216, v10, v49
    v_and_b32 v217, v10, v51
    v_mfma_f32_16x16x32_bf16 v[136:139], v[208:211], v[32:35], v[136:139]
    v_and_b32 v218, v10, v53
    v_and_b32 v219, v10, v55
    v_and_b32 v220, v10, v57
    v_and_b32 v221, v10, v59
    v_and_b32 v222, v10, v61
    v_and_b32 v223, v10, v63
    v_pk_mul_f32 v[216:217], v[216:217], v[188:189]
    v_pk_mul_f32 v[218:219], v[218:219], v[190:191]
    v_pk_mul_f32 v[220:221], v[220:221], v[204:205]
    v_pk_mul_f32 v[222:223], v[222:223], v[206:207]
    v_cvt_pk_bf16_f32 v216, v216, v217
    v_cvt_pk_bf16_f32 v217, v218, v219
    v_cvt_pk_bf16_f32 v218, v220, v221
    v_cvt_pk_bf16_f32 v219, v222, v223
    s_waitcnt vmcnt(8)
    v_lshlrev_b32 v224, 16, v64
    v_lshlrev_b32 v225, 16, v66
    v_mfma_f32_16x16x32_bf16 v[140:143], v[216:219], v[32:35], v[140:143]
    v_lshlrev_b32 v226, 16, v68
    v_lshlrev_b32 v227, 16, v70
    v_lshlrev_b32 v228, 16, v72
    v_lshlrev_b32 v229, 16, v74
    v_lshlrev_b32 v230, 16, v76
    v_lshlrev_b32 v231, 16, v78
    v_pk_mul_f32 v[224:225], v[224:225], v[176:177]
    v_pk_mul_f32 v[226:227], v[226:227], v[178:179]
    v_pk_mul_f32 v[228:229], v[228:229], v[192:193]
    v_pk_mul_f32 v[230:231], v[230:231], v[194:195]
    v_cvt_pk_bf16_f32 v224, v224, v225
    v_cvt_pk_bf16_f32 v225, v226, v227
    v_cvt_pk_bf16_f32 v226, v228, v229
    v_cvt_pk_bf16_f32 v227, v230, v231
    v_and_b32 v232, v10, v64
    v_and_b32 v233, v10, v66
    v_mfma_f32_16x16x32_bf16 v[144:147], v[224:227], v[32:35], v[144:147]
    v_and_b32 v234, v10, v68
    v_and_b32 v235, v10, v70
    v_and_b32 v236, v10, v72
    v_and_b32 v237, v10, v74
    v_and_b32 v238, v10, v76
    v_and_b32 v239, v10, v78
    v_pk_mul_f32 v[232:233], v[232:233], v[180:181]
    v_pk_mul_f32 v[234:235], v[234:235], v[182:183]
    v_pk_mul_f32 v[236:237], v[236:237], v[196:197]
    v_pk_mul_f32 v[238:239], v[238:239], v[198:199]
    v_cvt_pk_bf16_f32 v232, v232, v233
    v_cvt_pk_bf16_f32 v233, v234, v235
    v_cvt_pk_bf16_f32 v234, v236, v237
    v_cvt_pk_bf16_f32 v235, v238, v239
    v_cvt_pk_bf16_f32 v48, v112, v116
    v_cvt_pk_bf16_f32 v49, v120, v124
    v_cvt_pk_bf16_f32 v50, v113, v117
    v_cvt_pk_bf16_f32 v51, v121, v125
    v_cvt_pk_bf16_f32 v52, v114, v118
    v_cvt_pk_bf16_f32 v53, v122, v126
    v_cvt_pk_bf16_f32 v54, v115, v119
    v_cvt_pk_bf16_f32 v55, v123, v127
    v_cvt_pk_bf16_f32 v56, v128, v132
    v_cvt_pk_bf16_f32 v57, v136, v140
    v_cvt_pk_bf16_f32 v58, v129, v133
    v_cvt_pk_bf16_f32 v59, v137, v141
    v_cvt_pk_bf16_f32 v60, v130, v134
    v_cvt_pk_bf16_f32 v61, v138, v142
    v_cvt_pk_bf16_f32 v62, v131, v135
    v_cvt_pk_bf16_f32 v63, v139, v143
    s_mov_b64 exec, s[22:23]
    buffer_store_dwordx4 v[48:51], v16, s[40:43], 0 offen offset:0 sc1 nt
    buffer_store_dwordx4 v[52:55], v16, s[40:43], 0 offen offset:64 sc1 nt
    buffer_store_dwordx4 v[56:59], v16, s[40:43], 0 offen offset:128 sc1 nt
    buffer_store_dwordx4 v[60:63], v16, s[40:43], 0 offen offset:192 sc1 nt
    s_mov_b64 exec, -1
    v_lshlrev_b32 v208, 16, v65
    v_lshlrev_b32 v209, 16, v67
    v_mfma_f32_16x16x32_bf16 v[148:151], v[232:235], v[32:35], v[148:151]
    v_lshlrev_b32 v210, 16, v69
    v_lshlrev_b32 v211, 16, v71
    v_lshlrev_b32 v212, 16, v73
    v_lshlrev_b32 v213, 16, v75
    v_lshlrev_b32 v214, 16, v77
    v_lshlrev_b32 v215, 16, v79
    v_pk_mul_f32 v[208:209], v[208:209], v[184:185]
    v_pk_mul_f32 v[210:211], v[210:211], v[186:187]
    v_pk_mul_f32 v[212:213], v[212:213], v[200:201]
    v_pk_mul_f32 v[214:215], v[214:215], v[202:203]
    v_cvt_pk_bf16_f32 v208, v208, v209
    v_cvt_pk_bf16_f32 v209, v210, v211
    v_cvt_pk_bf16_f32 v210, v212, v213
    v_cvt_pk_bf16_f32 v211, v214, v215
    v_and_b32 v216, v10, v65
    v_and_b32 v217, v10, v67
    v_mfma_f32_16x16x32_bf16 v[152:155], v[208:211], v[32:35], v[152:155]
    v_and_b32 v218, v10, v69
    v_and_b32 v219, v10, v71
    v_and_b32 v220, v10, v73
    v_and_b32 v221, v10, v75
    v_and_b32 v222, v10, v77
    v_and_b32 v223, v10, v79
    v_pk_mul_f32 v[216:217], v[216:217], v[188:189]
    v_pk_mul_f32 v[218:219], v[218:219], v[190:191]
    v_pk_mul_f32 v[220:221], v[220:221], v[204:205]
    v_pk_mul_f32 v[222:223], v[222:223], v[206:207]
    v_cvt_pk_bf16_f32 v216, v216, v217
    v_cvt_pk_bf16_f32 v217, v218, v219
    v_cvt_pk_bf16_f32 v218, v220, v221
    v_cvt_pk_bf16_f32 v219, v222, v223
    s_waitcnt vmcnt(4)
    v_lshlrev_b32 v224, 16, v80
    v_lshlrev_b32 v225, 16, v82
    v_mfma_f32_16x16x32_bf16 v[156:159], v[216:219], v[32:35], v[156:159]
    v_lshlrev_b32 v226, 16, v84
    v_lshlrev_b32 v227, 16, v86
    v_lshlrev_b32 v228, 16, v88
    v_lshlrev_b32 v229, 16, v90
    v_lshlrev_b32 v230, 16, v92
    v_lshlrev_b32 v231, 16, v94
    v_pk_mul_f32 v[224:225], v[224:225], v[176:177]
    v_pk_mul_f32 v[226:227], v[226:227], v[178:179]
    v_pk_mul_f32 v[228:229], v[228:229], v[192:193]
    v_pk_mul_f32 v[230:231], v[230:231], v[194:195]
    v_cvt_pk_bf16_f32 v224, v224, v225
    v_cvt_pk_bf16_f32 v225, v226, v227
    v_cvt_pk_bf16_f32 v226, v228, v229
    v_cvt_pk_bf16_f32 v227, v230, v231
    v_and_b32 v232, v10, v80
    v_and_b32 v233, v10, v82
    v_mfma_f32_16x16x32_bf16 v[160:163], v[224:227], v[32:35], v[160:163]
    v_and_b32 v234, v10, v84
    v_and_b32 v235, v10, v86
    v_and_b32 v236, v10, v88
    v_and_b32 v237, v10, v90
    v_and_b32 v238, v10, v92
    v_and_b32 v239, v10, v94
    v_pk_mul_f32 v[232:233], v[232:233], v[180:181]
    v_pk_mul_f32 v[234:235], v[234:235], v[182:183]
    v_pk_mul_f32 v[236:237], v[236:237], v[196:197]
    v_pk_mul_f32 v[238:239], v[238:239], v[198:199]
    v_cvt_pk_bf16_f32 v232, v232, v233
    v_cvt_pk_bf16_f32 v233, v234, v235
    v_cvt_pk_bf16_f32 v234, v236, v237
    v_cvt_pk_bf16_f32 v235, v238, v239
    v_cvt_pk_bf16_f32 v64, v144, v148
    v_cvt_pk_bf16_f32 v65, v152, v156
    v_cvt_pk_bf16_f32 v66, v145, v149
    v_cvt_pk_bf16_f32 v67, v153, v157
    v_cvt_pk_bf16_f32 v68, v146, v150
    v_cvt_pk_bf16_f32 v69, v154, v158
    v_cvt_pk_bf16_f32 v70, v147, v151
    v_cvt_pk_bf16_f32 v71, v155, v159
    s_mov_b64 exec, s[22:23]
    buffer_store_dwordx4 v[64:67], v16, s[40:43], 0 offen offset:256 sc1 nt
    buffer_store_dwordx4 v[68:71], v16, s[40:43], 0 offen offset:320 sc1 nt
    s_mov_b64 exec, -1
    v_lshlrev_b32 v208, 16, v81
    v_lshlrev_b32 v209, 16, v83
    v_mfma_f32_16x16x32_bf16 v[164:167], v[232:235], v[32:35], v[164:167]
    v_lshlrev_b32 v210, 16, v85
    v_lshlrev_b32 v211, 16, v87
    v_lshlrev_b32 v212, 16, v89
    v_lshlrev_b32 v213, 16, v91
    v_lshlrev_b32 v214, 16, v93
    v_lshlrev_b32 v215, 16, v95
    v_pk_mul_f32 v[208:209], v[208:209], v[184:185]
    v_pk_mul_f32 v[210:211], v[210:211], v[186:187]
    v_pk_mul_f32 v[212:213], v[212:213], v[200:201]
    v_pk_mul_f32 v[214:215], v[214:215], v[202:203]
    v_cvt_pk_bf16_f32 v208, v208, v209
    v_cvt_pk_bf16_f32 v209, v210, v211
    v_cvt_pk_bf16_f32 v210, v212, v213
    v_cvt_pk_bf16_f32 v211, v214, v215
    v_and_b32 v216, v10, v81
    v_and_b32 v217, v10, v83
    v_mfma_f32_16x16x32_bf16 v[168:171], v[208:211], v[32:35], v[168:171]
    v_and_b32 v218, v10, v85
    v_and_b32 v219, v10, v87
    v_and_b32 v220, v10, v89
    v_and_b32 v221, v10, v91
    v_and_b32 v222, v10, v93
    v_and_b32 v223, v10, v95
    v_pk_mul_f32 v[216:217], v[216:217], v[188:189]
    v_pk_mul_f32 v[218:219], v[218:219], v[190:191]
    v_pk_mul_f32 v[220:221], v[220:221], v[204:205]
    v_pk_mul_f32 v[222:223], v[222:223], v[206:207]
    v_cvt_pk_bf16_f32 v216, v216, v217
    v_cvt_pk_bf16_f32 v217, v218, v219
    v_cvt_pk_bf16_f32 v218, v220, v221
    v_cvt_pk_bf16_f32 v219, v222, v223
    s_nop 1
    v_mfma_f32_16x16x32_bf16 v[172:175], v[216:219], v[32:35], v[172:175]
    v_cvt_pk_bf16_f32 v200, v160, v164
    s_nop 6
    v_cvt_pk_bf16_f32 v201, v168, v172
    v_cvt_pk_bf16_f32 v202, v161, v165
    v_cvt_pk_bf16_f32 v203, v169, v173
    v_cvt_pk_bf16_f32 v204, v162, v166
    v_cvt_pk_bf16_f32 v205, v170, v174
    v_cvt_pk_bf16_f32 v206, v163, v167
    v_cvt_pk_bf16_f32 v207, v171, v175
    s_mov_b64 exec, s[22:23]
    buffer_store_dwordx4 v[200:203], v16, s[40:43], 0 offen offset:384 sc1 nt
    buffer_store_dwordx4 v[204:207], v16, s[40:43], 0 offen offset:448 sc1 nt
    s_mov_b64 exec, -1
    s_nop 0
L2_rounddone:
    s_cmp_eq_u32 s87, 0
    s_cbranch_scc1 L2_fin
    s_waitcnt vmcnt(0) lgkmcnt(0)
    s_barrier
    s_cmp_ge_u32 s3, 2
    s_cbranch_scc1 L2_nozerob
    v_lshlrev_b32 v42, 2, v0
    v_mov_b32 v44, 0
    ds_write_b32 v42, v44 offset:24576
L2_nozerob:
    s_mul_i32 s46, s2, 51200
    s_add_u32 s44, s20, s46
    s_addc_u32 s45, s21, 0
    s_mov_b32 s46, 51200
    s_mov_b32 s47, 0x20000
    v_lshrrev_b32 v40, 9, v1
    v_add_u32 v188, 0, v40
    v_lshlrev_b32 v188, 5, v188
    v_xor_b32 v188, v188, v1
    v_add_u32 v189, 2, v40
    v_lshlrev_b32 v189, 5, v189
    v_xor_b32 v189, v189, v1
    v_add_u32 v190, 4, v40
    v_lshlrev_b32 v190, 5, v190
    v_xor_b32 v190, v190, v1
    v_add_u32 v191, 6, v40
    v_lshlrev_b32 v191, 5, v191
    v_xor_b32 v191, v191, v1
    s_lshl_b32 s89, s3, 12
    s_add_u32 m0, s89, 50176
    s_cmp_ge_u32 s3, 5
    buffer_load_dwordx4 v188, s[44:47], s89 offen offset:0 sc1 lds
    buffer_load_dwordx4 v189, s[44:47], s89 offen offset:1024 sc1 lds
    buffer_load_dwordx4 v190, s[44:47], s89 offen offset:2048 sc1 lds
    buffer_load_dwordx4 v191, s[44:47], s89 offen offset:3072 sc1 lds
    s_cbranch_scc1 L2_resdoneb
    s_add_u32 s89, s89, 32768
    s_add_u32 m0, s89, 50176
    s_cmp_eq_u32 s3, 4
    buffer_load_dwordx4 v188, s[44:47], s89 offen offset:0 sc1 lds
    buffer_load_dwordx4 v189, s[44:47], s89 offen offset:1024 sc1 lds
    s_cbranch_scc1 L2_resdoneb
    buffer_load_dwordx4 v190, s[44:47], s89 offen offset:2048 sc1 lds
    buffer_load_dwordx4 v191, s[44:47], s89 offen offset:3072 sc1 lds
L2_resdoneb:
    v_lshrrev_b32 v40, 2, v0
    v_mul_u32_u24 v41, 16512, v40
    buffer_load_dword v42, v41, s[48:51], 0 offen sc1
    v_add_u32 v41, 2113536, v41
    buffer_load_dword v43, v41, s[48:51], 0 offen sc1
    v_and_b32 v39, 3, v0
    v_lshlrev_b32 v39, 2, v39
    s_lshl_b32 s89, s88, 4
    s_add_u32 s90, s89, 15
    s_add_u32 s88, s88, 1
    v_mul_u32_u24 v40, 12800, v40
    v_lshl_add_u32 v40, v39, 2, v40
    s_lshl_b32 s89, s89, 2
    v_add_u32 v40, s89, v40
    s_waitcnt vmcnt(0)
    v_bfe_u32 v44, v42, 12, 12
    v_lshl_add_u32 v44, v44, 2, v40
    buffer_load_dwordx4 v[48:51], v44, s[80:83], 0 offen sc1
    v_and_b32 v58, 0xfff, v42
    v_subrev_u32 v58, s90, v58
    v_med3_i32 v56, v58, 0, 16
    v_subrev_u32 v58, 16, v58
    v_bfe_u32 v44, v43, 12, 12
    v_lshl_add_u32 v44, v44, 2, v40
    v_add_u32 v44, 1638400, v44
    buffer_load_dwordx4 v[52:55], v44, s[80:83], 0 offen sc1
    v_and_b32 v59, 0xfff, v43
    v_subrev_u32 v59, s90, v59
    v_med3_i32 v57, v59, 0, 16
    v_subrev_u32 v59, 16, v59
    s_waitcnt vmcnt(0) lgkmcnt(0)
    s_barrier
    s_branch L2_round
L2_fin:
L_end:
    s_endpgm
L1_ovf:
    s_cmp_ge_u32 s3, 4
    s_cbranch_scc1 L1_ovf_based
    v_lshlrev_b32 v40, 2, v0
    v_add_u32 v40, 151552, v40
    ds_read_b32 v41, v40
    s_waitcnt lgkmcnt(0)
    v_cmp_lt_u32 vcc, 15, v41
    s_nop 0
    s_and_saveexec_b64 s[88:89], vcc
    s_nop 2
    s_cbranch_execz L1_ovf_none
    v_subrev_u32 v41, 15, v41
    v_mov_b32 v42, 152576
    ds_add_rtn_u32 v43, v42, v41
    s_waitcnt lgkmcnt(0)
    ds_write_b32 v40, v43 offset:1280
L1_ovf_none:
    s_mov_b64 exec, s[88:89]
L1_ovf_based:
    s_waitcnt lgkmcnt(0)
    s_barrier
    s_mul_i32 s90, s2, 12800
    s_add_u32 s90, s90, 8388608
    s_add_u32 s88, s24, s90
    s_addc_u32 s89, s25, 0
    s_mov_b32 s90, 12800
    s_mov_b32 s91, 0x20000
    s_mov_b64 exec, -1
    v_cmp_le_u32 vcc, 15, v136
    s_nop 0
    s_and_b64 exec, vcc, s[64:65]
    s_nop 2
    s_cbranch_execz L1_ovf0
    ds_read_b32 v40, v80 offset:1280
    s_waitcnt lgkmcnt(0)
    v_add_u32 v40, v40, v136
    v_subrev_u32 v40, 15, v40
    v_lshlrev_b32 v40, 2, v40
    buffer_store_dword v96, v40, s[88:91], 0 offen sc1
    s_nop 0
L1_ovf0:
    s_mov_b64 exec, -1
    v_cmp_le_u32 vcc, 15, v137
    s_nop 0
    s_and_b64 exec, vcc, s[66:67]
    s_nop 2
    s_cbranch_execz L1_ovf1
    ds_read_b32 v40, v81 offset:1280
    s_waitcnt lgkmcnt(0)
    v_add_u32 v40, v40, v137
    v_subrev_u32 v40, 15, v40
    v_lshlrev_b32 v40, 2, v40
    buffer_store_dword v97, v40, s[88:91], 0 offen sc1
    s_nop 0
L1_ovf1:
    s_mov_b64 exec, -1
    v_cmp_le_u32 vcc, 15, v138
    s_nop 0
    s_and_b64 exec, vcc, s[68:69]
    s_nop 2
    s_cbranch_execz L1_ovf2
    ds_read_b32 v40, v82 offset:1280
    s_waitcnt lgkmcnt(0)
    v_add_u32 v40, v40, v138
    v_subrev_u32 v40, 15, v40
    v_lshlrev_b32 v40, 2, v40
    buffer_store_dword v98, v40, s[88:91], 0 offen sc1
    s_nop 0
L1_ovf2:
    s_mov_b64 exec, -1
    v_cmp_le_u32 vcc, 15, v139
    s_nop 0
    s_and_b64 exec, vcc, s[70:71]
    s_nop 2
    s_cbranch_execz L1_ovf3
    ds_read_b32 v40, v83 offset:1280
    s_waitcnt lgkmcnt(0)
    v_add_u32 v40, v40, v139
    v_subrev_u32 v40, 15, v40
    v_lshlrev_b32 v40, 2, v40
    buffer_store_dword v99, v40, s[88:91], 0 offen sc1
    s_nop 0
L1_ovf3:
    s_mov_b64 exec, -1
    v_cmp_le_u32 vcc, 15, v140
    s_nop 0
    s_and_b64 exec, vcc, s[72:73]
    s_nop 2
    s_cbranch_execz L1_ovf4
    ds_read_b32 v40, v84 offset:1280
    s_waitcnt lgkmcnt(0)
    v_add_u32 v40, v40, v140
    v_subrev_u32 v40, 15, v40
    v_lshlrev_b32 v40, 2, v40
    buffer_store_dword v100, v40, s[88:91], 0 offen sc1
    s_nop 0
L1_ovf4:
    s_mov_b64 exec, -1
    v_cmp_le_u32 vcc, 15, v141
    s_nop 0
    s_and_b64 exec, vcc, s[74:75]
    s_nop 2
    s_cbranch_execz L1_ovf5
    ds_read_b32 v40, v85 offset:1280
    s_waitcnt lgkmcnt(0)
    v_add_u32 v40, v40, v141
    v_subrev_u32 v40, 15, v40
    v_lshlrev_b32 v40, 2, v40
    buffer_store_dword v101, v40, s[88:91], 0 offen sc1
    s_nop 0
L1_ovf5:
    s_mov_b64 exec, -1
    v_cmp_le_u32 vcc, 15, v142
    s_nop 0
    s_and_b64 exec, vcc, s[76:77]
    s_nop 2
    s_cbranch_execz L1_ovf6
    ds_read_b32 v40, v86 offset:1280
    s_waitcnt lgkmcnt(0)
    v_add_u32 v40, v40, v142
    v_subrev_u32 v40, 15, v40
    v_lshlrev_b32 v40, 2, v40
    buffer_store_dword v102, v40, s[88:91], 0 offen sc1
    s_nop 0
L1_ovf6:
    s_mov_b64 exec, -1
    ds_read_b32 v40, v185 offset:1280
    v_cmp_lt_u32 vcc, 15, v108
    s_waitcnt lgkmcnt(0)
    v_lshlrev_b32 v40, 12, v40
    v_cndmask_b32_e64 v40, 0, v40, vcc
    v_or_b32 v108, v108, v40
    ds_read_b32 v40, v185 offset:1792
    v_cmp_lt_u32 vcc, 15, v109
    s_waitcnt lgkmcnt(0)
    v_lshlrev_b32 v40, 12, v40
    v_cndmask_b32_e64 v40, 0, v40, vcc
    v_or_b32 v109, v109, v40
    s_waitcnt vmcnt(0)
    s_barrier
    s_branch L1_noovf
.section .rodata,"a"
.p2align 6
.amdhsa_kernel gather_scatter__molecular_angular_painn__graph_kernel
  .amdhsa_next_free_vgpr 256
  .amdhsa_next_free_sgpr 102
  .amdhsa_accum_offset 256
  .amdhsa_group_segment_fixed_size 0
  .amdhsa_kernarg_size 88
  .amdhsa_user_sgpr_count 2
  .amdhsa_user_sgpr_kernarg_segment_ptr 1
  .amdhsa_system_sgpr_workgroup_id_x 1
  .amdhsa_float_denorm_mode_32 3
.end_amdhsa_kernel
```
